```python
import torch

def _softmax(x, axis=-1):
    return torch.softmax(x, dim=axis)
def _gelu(x):
    return torch.nn.functional.gelu(x, approximate="tanh")
def _silu(x):
    return torch.nn.functional.silu(x)
def _sigmoid(x):
    return torch.sigmoid(x)
def _layernorm(x, axis=-1, eps=1e-5):
    m = x.mean(dim=axis, keepdim=True)
    v = x.var(dim=axis, keepdim=True, unbiased=False)
    return (x - m) / torch.sqrt(v + eps)
def _scatter_add(tgt, idx, src, axis=0):
    return tgt.clone().index_add_(axis, idx, src)
def _segment_sum(src, seg, n):
    out = torch.zeros((n,) + src.shape[1:], dtype=src.dtype)
    return out.index_add_(0, seg, src)
def _pad(x, pw):
    flat = tuple(v for pair in reversed(pw) for v in pair)
    return torch.nn.functional.pad(x, flat)

kernel_name = 'gated_mix__mha_block__dense_activation_squared_relu__prompt'

def setup_inputs():

    _w = (lambda a: (lambda t: t.to(torch.bfloat16) if t.is_floating_point() else t)(torch.as_tensor(a)))
    def _A_setup():
        B, S, D, H = 1, 2048, 512, 32
        return {
            "x": _w((lambda *s: torch.randn(*s, dtype=torch.bfloat16) * 0.05)(B, S, D)),
            "wqkv": _w((lambda *s: torch.randn(*s, dtype=torch.bfloat16) * 0.8)(D, 3 * D)),
            "wo": _w((lambda *s: torch.randn(*s, dtype=torch.bfloat16) * 0.1)(D, D)),
        }
    _A_in = _A_setup()

    def _B_setup():
        B, S, D, F = 1, 2048, 512, 1376
        return {
            "x": _w((lambda *s: torch.randn(*s, dtype=torch.bfloat16) * 0.05)(B, S, D)),
            "w1": _w((lambda *s: torch.randn(*s, dtype=torch.bfloat16) * 0.1)(D, F)),
            "b1": _w((lambda *s: torch.randn(*s, dtype=torch.bfloat16) * 0.1)(F)),
            "w2": _w((lambda *s: torch.randn(*s, dtype=torch.bfloat16) * 0.1)(F, D)),
            "b2": _w((lambda *s: torch.randn(*s, dtype=torch.bfloat16) * 0.05)(D)),
        }
    _B_in = _B_setup()

    return {
        "A_x": _A_in["x"],
        "A_wqkv": _A_in["wqkv"],
        "A_wo": _A_in["wo"],
        "B_x": _B_in["x"],
        "B_w1": _B_in["w1"],
        "B_b1": _B_in["b1"],
        "B_w2": _B_in["w2"],
        "B_b2": _B_in["b2"],
        "gate_w": _w((lambda *s: torch.randn(*s, dtype=torch.bfloat16) * 0.05)(512) * 16.0),
    }

def reference(A_x, A_wqkv, A_wo, B_x, B_w1, B_b1, B_w2, B_b2, gate_w):
    def _A_ref(x, wqkv, wo):
        B, S, D = x.shape
        H = 32
        Dh = D // H
        qkv = (lambda x, *d: x.permute(*d))((x @ wqkv).reshape(B, S, 3, H, Dh), 2, 0, 3, 1, 4)
        q, k, v = qkv[0], qkv[1], qkv[2]
        scores = torch.einsum("bhqd,bhkd->bhqk", q, k) * (Dh ** -0.5)
        p = _softmax(scores, axis=-1)
        o = torch.einsum("bhqk,bhkd->bhqd", p, v)
        return (lambda x, *d: x.permute(*d))(o, 0, 2, 1, 3).reshape(B, S, D) @ wo

    def _B_ref(x, w1, b1, w2, b2):
        h = torch.einsum("bsd,df->bsf", x, w1) + b1
        zero = torch.zeros_like(h)
        r = torch.where(h > zero, h, zero)
        h = r * r
        out = torch.einsum("bsf,fd->bsd", h, w2) + b2
        return out

    x = A_x
    g = _sigmoid((x * gate_w).sum(-1, keepdims=True))
    a = _A_ref(x, A_wqkv, A_wo)
    b = _B_ref(x, B_w1, B_b1, B_w2, B_b2)
    return g * a + (1 - g) * b
```

```asm
; @launch grid=(256,1,1) block=(512,1,1) lds=163840
.amdgcn_target "amdgcn-amd-amdhsa--gfx950"
.text
.globl gated_mix__mha_block__dense_activation_squared_relu__prompt_kernel
.p2align 8
.type gated_mix__mha_block__dense_activation_squared_relu__prompt_kernel,@function
gated_mix__mha_block__dense_activation_squared_relu__prompt_kernel:
    s_cmp_ge_u32 s2, 256
    s_cbranch_scc1 L_gated_mix__mha_block__dense_activation_squared_relu__prompt_kernel_end
    s_load_dwordx4 s[92:95], s[0:1], 48
    s_load_dwordx2 s[96:97], s[0:1], 16
    s_load_dwordx2 s[98:99], s[0:1], 72
    s_load_dwordx4 s[4:7], s[0:1], 0
    s_load_dwordx4 s[40:43], s[0:1], 32
    s_load_dwordx2 s[44:45], s[0:1], 64
    s_load_dwordx2 s[8:9], s[0:1], 88
    v_lshrrev_b32 v1, 6, v0
    v_and_b32 v0, 63, v0
    v_readfirstlane_b32 s3, v1
    s_lshr_b32 s46, s2, 3
    s_and_b32 s47, s2, 1
    s_lshl_b32 s47, s47, 3
    s_and_b32 s48, s46, 7
    s_add_u32 s37, s47, s48
    s_lshr_b32 s47, s2, 1
    s_and_b32 s47, s47, 3
    s_lshl_b32 s47, s47, 2
    s_lshr_b32 s49, s46, 3
    s_add_u32 s38, s47, s49
    s_lshl_b32 s49, s49, 1
    s_add_u32 s49, s49, s48
    s_add_u32 s49, s38, s37
    s_and_b32 s49, s49, 7
    s_mul_i32 s39, s49, 1
    s_cmp_lg_u32 s3, 7
    s_cbranch_scc1 L_gated_mix__mha_block__dense_activation_squared_relu__prompt_kernel_nocpf
    s_getpc_b64 s[46:47]
L_gated_mix__mha_block__dense_activation_squared_relu__prompt_kernel_pcbase:
    s_sub_u32 s52, s46, L_gated_mix__mha_block__dense_activation_squared_relu__prompt_kernel_pcbase-gated_mix__mha_block__dense_activation_squared_relu__prompt_kernel
    s_subb_u32 s53, s47, 0
    s_mov_b32 s54, L_gated_mix__mha_block__dense_activation_squared_relu__prompt_kernel_codeend-gated_mix__mha_block__dense_activation_squared_relu__prompt_kernel
    s_mov_b32 s55, 0x20000
    s_lshr_b32 s56, s2, 3
    s_mul_i32 s56, s56, 16
    v_add_u32 v1, s56, v0
    v_lshlrev_b32 v1, 7, v1
    s_mov_b64 exec, 0xffff
    buffer_load_dword v254, v1, s[52:55], 0 offen
    s_mov_b64 exec, -1
L_gated_mix__mha_block__dense_activation_squared_relu__prompt_kernel_nocpf:
    s_cmp_ge_u32 s3, 4
    s_cbranch_scc0 L_gated_mix__mha_block__dense_activation_squared_relu__prompt_kernel_compute
    s_sub_u32 s50, s3, 4
    v_lshrrev_b32 v2, 3, v0
    v_and_b32 v3, 7, v0
    v_lshrrev_b32 v4, 4, v0
    s_and_b32 s51, s50, 1
    s_lshl_b32 s52, s51, 2
    v_add_u32 v4, s52, v4
    v_xor_b32 v3, v3, v4
    v_lshlrev_b32 v2, 10, v2
    v_lshlrev_b32 v3, 4, v3
    v_add_u32 v10, v2, v3
    s_movk_i32 s53, 3072
    s_movk_i32 s54, 2752
    v_add_u32 v2, 0, v0
    v_mul_u32_u24 v3, 0xaaab, v2
    v_lshrrev_b32 v3, 19, v3
    v_mul_u32_u24 v4, 12, v3
    v_sub_u32 v4, v2, v4
    v_lshlrev_b32 v4, 4, v4
    v_mul_u32_u24 v7, s53, v3
    v_add_u32 v11, v7, v4
    v_mul_u32_u24 v7, s54, v3
    v_add_u32 v14, v7, v4
    v_add_u32 v2, 64, v0
    v_mul_u32_u24 v3, 0xaaab, v2
    v_lshrrev_b32 v3, 19, v3
    v_mul_u32_u24 v4, 12, v3
    v_sub_u32 v4, v2, v4
    v_lshlrev_b32 v4, 4, v4
    v_mul_u32_u24 v7, s53, v3
    v_add_u32 v12, v7, v4
    v_mul_u32_u24 v7, s54, v3
    v_add_u32 v15, v7, v4
    v_add_u32 v2, 128, v0
    v_mul_u32_u24 v3, 0xaaab, v2
    v_lshrrev_b32 v3, 19, v3
    v_mul_u32_u24 v4, 12, v3
    v_sub_u32 v4, v2, v4
    v_lshlrev_b32 v4, 4, v4
    v_mul_u32_u24 v7, s53, v3
    v_add_u32 v13, v7, v4
    v_mul_u32_u24 v7, s54, v3
    v_add_u32 v16, v7, v4
    s_lshl_b32 s55, s37, 17
    s_lshl_b32 s56, s50, 13
    s_add_u32 s55, s55, s56
    s_lshl_b32 s56, s50, 4
    s_mul_i32 s57, s56, 3072
    s_mul_i32 s58, s38, 192
    s_add_u32 s57, s57, s58
    s_mul_i32 s58, s56, 2752
    s_mul_i32 s59, s38, 192
    s_add_u32 s58, s58, s59
    s_lshl_b32 s59, s50, 10
    s_mul_i32 s60, s50, 3072
    s_add_u32 s60, s60, 16384
    s_waitcnt lgkmcnt(0)
    s_mov_b32 s12, s4
    s_mov_b32 s13, s5
    s_mov_b32 s14, 0x200000
    s_mov_b32 s15, 0x20000
    s_mov_b32 s16, s6
    s_mov_b32 s17, s7
    s_mov_b32 s18, 0x180000
    s_mov_b32 s19, 0x20000
    s_mov_b32 s20, s8
    s_mov_b32 s21, s9
    s_mov_b32 s22, 0x1400000
    s_mov_b32 s23, 0x20000
    s_mov_b32 s28, s40
    s_mov_b32 s29, s41
    s_mov_b32 s30, 0x158000
    s_mov_b32 s31, 0x20000
    s_mov_b32 s24, s42
    s_mov_b32 s25, s43
    s_mov_b32 s26, 0xac0
    s_mov_b32 s27, 0x20000
    s_mov_b32 s32, s44
    s_mov_b32 s33, s45
    s_mov_b32 s34, 0x400
    s_mov_b32 s35, 0x20000
    v_mov_b32 v228, 0
    s_mov_b32 s46, 0xe46000
    buffer_load_dword v228, v228, s[20:23], s46 offen sc1
    v_lshlrev_b32 v2, 4, v0
    s_mov_b32 m0, 155648
    s_nop 0
    buffer_load_dwordx4 v2, s[32:35], 0 offen lds
    s_add_u32 s61, s39, 0
    s_and_b32 s61, s61, 7
    s_lshl_b32 s62, s61, 7
    s_add_u32 s62, s62, s55
    s_add_u32 m0, s59, 0
    s_add_u32 s63, s62, 0
    buffer_load_dwordx4 v10, s[12:15], s63 offen lds
    s_add_u32 m0, s59, 4096
    s_add_u32 s63, s62, 32768
    buffer_load_dwordx4 v10, s[12:15], s63 offen lds
    s_add_u32 m0, s59, 8192
    s_add_u32 s63, s62, 65536
    buffer_load_dwordx4 v10, s[12:15], s63 offen lds
    s_add_u32 m0, s59, 12288
    s_add_u32 s63, s62, 98304
    buffer_load_dwordx4 v10, s[12:15], s63 offen lds
    s_mul_i32 s63, s61, 196608
    s_add_u32 s63, s63, s57
    s_add_u32 m0, s60, 0
    s_nop 0
    buffer_load_dwordx4 v11, s[16:19], s63 offen lds
    s_add_u32 m0, s60, 1024
    s_nop 0
    buffer_load_dwordx4 v12, s[16:19], s63 offen lds
    s_add_u32 m0, s60, 2048
    s_nop 0
    buffer_load_dwordx4 v13, s[16:19], s63 offen lds
    s_add_u32 s61, s39, 1
    s_and_b32 s61, s61, 7
    s_lshl_b32 s62, s61, 7
    s_add_u32 s62, s62, s55
    s_add_u32 m0, s59, 28672
    s_add_u32 s63, s62, 0
    buffer_load_dwordx4 v10, s[12:15], s63 offen lds
    s_add_u32 m0, s59, 32768
    s_add_u32 s63, s62, 32768
    buffer_load_dwordx4 v10, s[12:15], s63 offen lds
    s_add_u32 m0, s59, 36864
    s_add_u32 s63, s62, 65536
    buffer_load_dwordx4 v10, s[12:15], s63 offen lds
    s_add_u32 m0, s59, 40960
    s_add_u32 s63, s62, 98304
    buffer_load_dwordx4 v10, s[12:15], s63 offen lds
    s_mul_i32 s63, s61, 196608
    s_add_u32 s63, s63, s57
    s_add_u32 m0, s60, 28672
    s_nop 0
    buffer_load_dwordx4 v11, s[16:19], s63 offen lds
    s_add_u32 m0, s60, 29696
    s_nop 0
    buffer_load_dwordx4 v12, s[16:19], s63 offen lds
    s_add_u32 m0, s60, 30720
    s_nop 0
    buffer_load_dwordx4 v13, s[16:19], s63 offen lds
    s_waitcnt vmcnt(7)
    v_add_u32 v228, 1, v228
    s_nop 0
    v_readfirstlane_b32 s36, v228
    s_barrier
    s_add_u32 s61, s39, 2
    s_and_b32 s61, s61, 7
    s_lshl_b32 s62, s61, 7
    s_add_u32 s62, s62, s55
    s_add_u32 m0, s59, 57344
    s_add_u32 s63, s62, 0
    buffer_load_dwordx4 v10, s[12:15], s63 offen lds
    s_add_u32 m0, s59, 61440
    s_add_u32 s63, s62, 32768
    buffer_load_dwordx4 v10, s[12:15], s63 offen lds
    s_add_u32 m0, s59, 65536
    s_add_u32 s63, s62, 65536
    buffer_load_dwordx4 v10, s[12:15], s63 offen lds
    s_add_u32 m0, s59, 69632
    s_add_u32 s63, s62, 98304
    buffer_load_dwordx4 v10, s[12:15], s63 offen lds
    s_mul_i32 s63, s61, 196608
    s_add_u32 s63, s63, s57
    s_add_u32 m0, s60, 57344
    s_nop 0
    buffer_load_dwordx4 v11, s[16:19], s63 offen lds
    s_add_u32 m0, s60, 58368
    s_nop 0
    buffer_load_dwordx4 v12, s[16:19], s63 offen lds
    s_add_u32 m0, s60, 59392
    s_nop 0
    buffer_load_dwordx4 v13, s[16:19], s63 offen lds
    s_add_u32 s61, s39, 3
    s_and_b32 s61, s61, 7
    s_lshl_b32 s62, s61, 7
    s_add_u32 s62, s62, s55
    s_add_u32 m0, s59, 86016
    s_add_u32 s63, s62, 0
    buffer_load_dwordx4 v10, s[12:15], s63 offen lds
    s_add_u32 m0, s59, 90112
    s_add_u32 s63, s62, 32768
    buffer_load_dwordx4 v10, s[12:15], s63 offen lds
    s_add_u32 m0, s59, 94208
    s_add_u32 s63, s62, 65536
    buffer_load_dwordx4 v10, s[12:15], s63 offen lds
    s_add_u32 m0, s59, 98304
    s_add_u32 s63, s62, 98304
    buffer_load_dwordx4 v10, s[12:15], s63 offen lds
    s_mul_i32 s63, s61, 196608
    s_add_u32 s63, s63, s57
    s_add_u32 m0, s60, 86016
    s_nop 0
    buffer_load_dwordx4 v11, s[16:19], s63 offen lds
    s_add_u32 m0, s60, 87040
    s_nop 0
    buffer_load_dwordx4 v12, s[16:19], s63 offen lds
    s_add_u32 m0, s60, 88064
    s_nop 0
    buffer_load_dwordx4 v13, s[16:19], s63 offen lds
    s_add_u32 s61, s39, 4
    s_and_b32 s61, s61, 7
    s_lshl_b32 s62, s61, 7
    s_add_u32 s62, s62, s55
    s_add_u32 m0, s59, 114688
    s_add_u32 s63, s62, 0
    buffer_load_dwordx4 v10, s[12:15], s63 offen lds
    s_add_u32 m0, s59, 118784
    s_add_u32 s63, s62, 32768
    buffer_load_dwordx4 v10, s[12:15], s63 offen lds
    s_add_u32 m0, s59, 122880
    s_add_u32 s63, s62, 65536
    buffer_load_dwordx4 v10, s[12:15], s63 offen lds
    s_add_u32 m0, s59, 126976
    s_add_u32 s63, s62, 98304
    buffer_load_dwordx4 v10, s[12:15], s63 offen lds
    s_mul_i32 s63, s61, 196608
    s_add_u32 s63, s63, s57
    s_add_u32 m0, s60, 114688
    s_nop 0
    buffer_load_dwordx4 v11, s[16:19], s63 offen lds
    s_add_u32 m0, s60, 115712
    s_nop 0
    buffer_load_dwordx4 v12, s[16:19], s63 offen lds
    s_add_u32 m0, s60, 116736
    s_nop 0
    buffer_load_dwordx4 v13, s[16:19], s63 offen lds
    s_waitcnt vmcnt(21)
    s_barrier
    s_add_u32 s61, s39, 5
    s_and_b32 s61, s61, 7
    s_lshl_b32 s62, s61, 7
    s_add_u32 s62, s62, s55
    s_add_u32 m0, s59, 0
    s_add_u32 s63, s62, 0
    buffer_load_dwordx4 v10, s[12:15], s63 offen lds
    s_add_u32 m0, s59, 4096
    s_add_u32 s63, s62, 32768
    buffer_load_dwordx4 v10, s[12:15], s63 offen lds
    s_add_u32 m0, s59, 8192
    s_add_u32 s63, s62, 65536
    buffer_load_dwordx4 v10, s[12:15], s63 offen lds
    s_add_u32 m0, s59, 12288
    s_add_u32 s63, s62, 98304
    buffer_load_dwordx4 v10, s[12:15], s63 offen lds
    s_mul_i32 s63, s61, 196608
    s_add_u32 s63, s63, s57
    s_add_u32 m0, s60, 0
    s_nop 0
    buffer_load_dwordx4 v11, s[16:19], s63 offen lds
    s_add_u32 m0, s60, 1024
    s_nop 0
    buffer_load_dwordx4 v12, s[16:19], s63 offen lds
    s_add_u32 m0, s60, 2048
    s_nop 0
    buffer_load_dwordx4 v13, s[16:19], s63 offen lds
    s_waitcnt vmcnt(21)
    s_barrier
    s_add_u32 s61, s39, 6
    s_and_b32 s61, s61, 7
    s_lshl_b32 s62, s61, 7
    s_add_u32 s62, s62, s55
    s_add_u32 m0, s59, 28672
    s_add_u32 s63, s62, 0
    buffer_load_dwordx4 v10, s[12:15], s63 offen lds
    s_add_u32 m0, s59, 32768
    s_add_u32 s63, s62, 32768
    buffer_load_dwordx4 v10, s[12:15], s63 offen lds
    s_add_u32 m0, s59, 36864
    s_add_u32 s63, s62, 65536
    buffer_load_dwordx4 v10, s[12:15], s63 offen lds
    s_add_u32 m0, s59, 40960
    s_add_u32 s63, s62, 98304
    buffer_load_dwordx4 v10, s[12:15], s63 offen lds
    s_mul_i32 s63, s61, 196608
    s_add_u32 s63, s63, s57
    s_add_u32 m0, s60, 28672
    s_nop 0
    buffer_load_dwordx4 v11, s[16:19], s63 offen lds
    s_add_u32 m0, s60, 29696
    s_nop 0
    buffer_load_dwordx4 v12, s[16:19], s63 offen lds
    s_add_u32 m0, s60, 30720
    s_nop 0
    buffer_load_dwordx4 v13, s[16:19], s63 offen lds
    s_waitcnt vmcnt(21)
    s_barrier
    s_add_u32 s61, s39, 7
    s_and_b32 s61, s61, 7
    s_lshl_b32 s62, s61, 7
    s_add_u32 s62, s62, s55
    s_add_u32 m0, s59, 57344
    s_add_u32 s63, s62, 0
    buffer_load_dwordx4 v10, s[12:15], s63 offen lds
    s_add_u32 m0, s59, 61440
    s_add_u32 s63, s62, 32768
    buffer_load_dwordx4 v10, s[12:15], s63 offen lds
    s_add_u32 m0, s59, 65536
    s_add_u32 s63, s62, 65536
    buffer_load_dwordx4 v10, s[12:15], s63 offen lds
    s_add_u32 m0, s59, 69632
    s_add_u32 s63, s62, 98304
    buffer_load_dwordx4 v10, s[12:15], s63 offen lds
    s_mul_i32 s63, s61, 196608
    s_add_u32 s63, s63, s57
    s_add_u32 m0, s60, 57344
    s_nop 0
    buffer_load_dwordx4 v11, s[16:19], s63 offen lds
    s_add_u32 m0, s60, 58368
    s_nop 0
    buffer_load_dwordx4 v12, s[16:19], s63 offen lds
    s_add_u32 m0, s60, 59392
    s_nop 0
    buffer_load_dwordx4 v13, s[16:19], s63 offen lds
    s_waitcnt vmcnt(21)
    s_barrier
    s_add_u32 s61, s39, 0
    s_and_b32 s61, s61, 7
    s_mul_i32 s63, s61, 176128
    s_add_u32 s63, s63, s58
    s_add_u32 m0, s60, 86016
    s_nop 0
    buffer_load_dwordx4 v14, s[28:31], s63 offen lds
    s_add_u32 m0, s60, 87040
    s_nop 0
    buffer_load_dwordx4 v15, s[28:31], s63 offen lds
    s_add_u32 m0, s60, 88064
    s_nop 0
    buffer_load_dwordx4 v16, s[28:31], s63 offen lds
    s_waitcnt vmcnt(17)
    s_barrier
    s_add_u32 s61, s39, 1
    s_and_b32 s61, s61, 7
    s_mul_i32 s63, s61, 176128
    s_add_u32 s63, s63, s58
    s_add_u32 m0, s60, 114688
    s_nop 0
    buffer_load_dwordx4 v14, s[28:31], s63 offen lds
    s_add_u32 m0, s60, 115712
    s_nop 0
    buffer_load_dwordx4 v15, s[28:31], s63 offen lds
    s_add_u32 m0, s60, 116736
    s_nop 0
    buffer_load_dwordx4 v16, s[28:31], s63 offen lds
    s_waitcnt vmcnt(13)
    s_barrier
    s_add_u32 s61, s39, 2
    s_and_b32 s61, s61, 7
    s_mul_i32 s63, s61, 176128
    s_add_u32 s63, s63, s58
    s_add_u32 m0, s60, 0
    s_nop 0
    buffer_load_dwordx4 v14, s[28:31], s63 offen lds
    s_add_u32 m0, s60, 1024
    s_nop 0
    buffer_load_dwordx4 v15, s[28:31], s63 offen lds
    s_add_u32 m0, s60, 2048
    s_nop 0
    buffer_load_dwordx4 v16, s[28:31], s63 offen lds
    s_waitcnt vmcnt(9)
    s_barrier
    s_add_u32 s61, s39, 3
    s_and_b32 s61, s61, 7
    s_mul_i32 s63, s61, 176128
    s_add_u32 s63, s63, s58
    s_add_u32 m0, s60, 28672
    s_nop 0
    buffer_load_dwordx4 v14, s[28:31], s63 offen lds
    s_add_u32 m0, s60, 29696
    s_nop 0
    buffer_load_dwordx4 v15, s[28:31], s63 offen lds
    s_add_u32 m0, s60, 30720
    s_nop 0
    buffer_load_dwordx4 v16, s[28:31], s63 offen lds
    s_waitcnt vmcnt(9)
    s_barrier
    s_add_u32 s61, s39, 4
    s_and_b32 s61, s61, 7
    s_mul_i32 s63, s61, 176128
    s_add_u32 s63, s63, s58
    s_add_u32 m0, s60, 57344
    s_nop 0
    buffer_load_dwordx4 v14, s[28:31], s63 offen lds
    s_add_u32 m0, s60, 58368
    s_nop 0
    buffer_load_dwordx4 v15, s[28:31], s63 offen lds
    s_add_u32 m0, s60, 59392
    s_nop 0
    buffer_load_dwordx4 v16, s[28:31], s63 offen lds
    s_waitcnt vmcnt(9)
    s_barrier
    s_waitcnt vmcnt(6)
    s_barrier
    s_add_u32 s61, s39, 5
    s_and_b32 s61, s61, 7
    s_mul_i32 s63, s61, 176128
    s_add_u32 s63, s63, s58
    s_add_u32 m0, s60, 86016
    s_nop 0
    buffer_load_dwordx4 v14, s[28:31], s63 offen lds
    s_add_u32 m0, s60, 87040
    s_nop 0
    buffer_load_dwordx4 v15, s[28:31], s63 offen lds
    s_add_u32 m0, s60, 88064
    s_nop 0
    buffer_load_dwordx4 v16, s[28:31], s63 offen lds
    s_waitcnt vmcnt(6)
    s_barrier
    s_cmp_lg_u32 s50, 1
    s_cbranch_scc1 L_gated_mix__mha_block__dense_activation_squared_relu__prompt_kernel_nopub
    s_mul_i32 s62, s38, 3
    v_add_u32 v2, s62, v0
    v_lshrrev_b32 v3, 4, v2
    v_lshlrev_b32 v3, 6, v3
    v_and_b32 v2, 15, v2
    v_lshlrev_b32 v2, 8, v2
    v_add_u32 v2, v2, v3
    s_lshl_b32 s62, s37, 2
    s_add_u32 s62, s62, 0xe40000
    v_mov_b32 v3, s36
    s_mov_b64 exec, 7
    buffer_store_dword v3, v2, s[20:23], s62 offen sc1
    s_mov_b64 exec, -1
L_gated_mix__mha_block__dense_activation_squared_relu__prompt_kernel_nopub:
    s_add_u32 s61, s39, 6
    s_and_b32 s61, s61, 7
    s_mul_i32 s63, s61, 176128
    s_add_u32 s63, s63, s58
    s_add_u32 m0, s60, 114688
    s_nop 0
    buffer_load_dwordx4 v14, s[28:31], s63 offen lds
    s_add_u32 m0, s60, 115712
    s_nop 0
    buffer_load_dwordx4 v15, s[28:31], s63 offen lds
    s_add_u32 m0, s60, 116736
    s_nop 0
    buffer_load_dwordx4 v16, s[28:31], s63 offen lds
    s_waitcnt vmcnt(6)
    s_barrier
    s_add_u32 s61, s39, 7
    s_and_b32 s61, s61, 7
    s_mul_i32 s63, s61, 176128
    s_add_u32 s63, s63, s58
    s_add_u32 m0, s60, 0
    s_nop 0
    buffer_load_dwordx4 v14, s[28:31], s63 offen lds
    s_add_u32 m0, s60, 1024
    s_nop 0
    buffer_load_dwordx4 v15, s[28:31], s63 offen lds
    s_add_u32 m0, s60, 2048
    s_nop 0
    buffer_load_dwordx4 v16, s[28:31], s63 offen lds
    s_waitcnt vmcnt(6)
    s_barrier
    s_waitcnt vmcnt(3)
    s_barrier
    s_waitcnt vmcnt(0)
    s_barrier
    s_mov_b32 s34, 0
    s_and_b32 s40, s2, 7
    s_lshl_b32 s41, s40, 2
    s_lshr_b32 s42, s2, 3
    s_and_b32 s43, s42, 3
    s_add_u32 s41, s41, s43
    s_lshr_b32 s44, s2, 5
    s_lshl_b32 s45, s41, 16
    s_lshr_b32 s46, s41, 1
    s_lshl_b32 s46, s46, 8
    s_add_u32 s46, s46, 0xe40000
    v_min_u32 v2, 47, v0
    v_lshlrev_b32 v2, 2, v2
    v_mov_b32 v4, 156672
    s_cmp_lg_u32 s3, 4
    s_cbranch_scc1 L_gated_mix__mha_block__dense_activation_squared_relu__prompt_kernel_ldswait
    s_mov_b32 s52, 16384
L_gated_mix__mha_block__dense_activation_squared_relu__prompt_kernel_pollq:
    buffer_load_dword v3, v2, s[20:23], s46 offen sc1
    s_waitcnt vmcnt(0)
    v_cmp_ne_u32 s[54:55], s36, v3
    s_nop 1
    s_cmp_eq_u64 s[54:55], 0
    s_cbranch_scc1 L_gated_mix__mha_block__dense_activation_squared_relu__prompt_kernel_pollq_ok
    s_sleep 6
    s_sub_u32 s52, s52, 1
    s_cmp_lg_u32 s52, 0
    s_cbranch_scc1 L_gated_mix__mha_block__dense_activation_squared_relu__prompt_kernel_pollq
L_gated_mix__mha_block__dense_activation_squared_relu__prompt_kernel_pollq_ok:
    v_mov_b32 v3, s36
    ds_write_b32 v4, v3
    s_branch L_gated_mix__mha_block__dense_activation_squared_relu__prompt_kernel_qready
L_gated_mix__mha_block__dense_activation_squared_relu__prompt_kernel_ldswait:
    s_mov_b32 s52, 131072
L_gated_mix__mha_block__dense_activation_squared_relu__prompt_kernel_ldsw:
    ds_read_b32 v3, v4
    s_waitcnt lgkmcnt(0)
    v_readfirstlane_b32 s53, v3
    s_nop 3
    s_cmp_eq_u32 s53, s36
    s_cbranch_scc1 L_gated_mix__mha_block__dense_activation_squared_relu__prompt_kernel_qready
    s_sleep 2
    s_sub_u32 s52, s52, 1
    s_cmp_lg_u32 s52, 0
    s_cbranch_scc1 L_gated_mix__mha_block__dense_activation_squared_relu__prompt_kernel_ldsw
L_gated_mix__mha_block__dense_activation_squared_relu__prompt_kernel_qready:
    v_lshlrev_b32 v2, 4, v0
    s_sub_u32 s50, s3, 4
    s_lshl_b32 s51, s50, 11
    s_add_u32 s47, s45, s51
    s_lshl_b32 s46, s44, 13
    s_add_u32 s46, s46, s47
    s_lshl_b32 s49, s50, 12
    s_add_u32 m0, s49, 0
    s_add_u32 s48, s47, 0x200000
    buffer_load_dwordx4 v2, s[20:23], s48 offen sc1 lds
    s_add_u32 m0, s51, 143360
    s_add_u32 s48, s46, 0
    buffer_load_dwordx4 v2, s[20:23], s48 offen sc1 lds
    s_add_u32 m0, s49, 1024
    s_add_u32 s48, s47, 0x400000
    buffer_load_dwordx4 v2, s[20:23], s48 offen sc1 lds
    s_add_u32 m0, s49, 2048
    s_add_u32 s48, s47, 0x200400
    buffer_load_dwordx4 v2, s[20:23], s48 offen sc1 lds
    s_add_u32 m0, s51, 144384
    s_add_u32 s48, s46, 1024
    buffer_load_dwordx4 v2, s[20:23], s48 offen sc1 lds
    s_add_u32 m0, s49, 3072
    s_add_u32 s48, s47, 0x400400
    buffer_load_dwordx4 v2, s[20:23], s48 offen sc1 lds
    s_waitcnt vmcnt(0)
    s_branch L_gated_mix__mha_block__dense_activation_squared_relu__prompt_kernel_p2
L_gated_mix__mha_block__dense_activation_squared_relu__prompt_kernel_compute:
    v_and_b32 v1, 31, v0
    s_lshl_b32 s50, s3, 5
    v_add_u32 v1, s50, v1
    v_lshlrev_b32 v1, 7, v1
    v_lshrrev_b32 v2, 5, v0
    v_lshrrev_b32 v3, 1, v0
    v_and_b32 v3, 7, v3
    v_xor_b32 v3, v3, v2
    v_lshlrev_b32 v3, 4, v3
    v_add_u32 v4, v1, v3
    v_xor_b32 v5, 32, v4
    v_xor_b32 v6, 64, v4
    v_xor_b32 v7, 96, v4
    v_add_u32 v8, 57344, v4
    v_add_u32 v9, 57344, v5
    v_add_u32 v10, 57344, v6
    v_add_u32 v11, 57344, v7
    v_add_u32 v12, 114688, v4
    v_add_u32 v13, 114688, v5
    v_add_u32 v14, 114688, v6
    v_add_u32 v15, 114688, v7
    v_lshlrev_b32 v1, 3, v2
    v_and_b32 v3, 15, v0
    v_lshrrev_b32 v3, 2, v3
    v_add_u32 v1, v1, v3
    v_mul_u32_u24 v1, 192, v1
    v_lshrrev_b32 v3, 4, v0
    v_and_b32 v3, 1, v3
    v_lshlrev_b32 v3, 5, v3
    v_add_u32 v1, v1, v3
    v_and_b32 v3, 3, v0
    v_lshlrev_b32 v3, 3, v3
    v_add_u32 v1, v1, v3
    v_add_u32 v229, 16384, v1
    v_add_u32 v230, 57344, v229
    v_add_u32 v231, 114688, v229
    s_mul_i32 s46, s38, 3
    s_add_u32 s46, s46, 0
    s_cmp_lt_u32 s46, 16
    s_mov_b32 s58, 1.0
    s_cselect_b32 s58, 0x3eb8aa3b, s58
    s_mov_b32 s59, s58
    s_mul_i32 s46, s38, 3
    s_add_u32 s46, s46, 1
    s_cmp_lt_u32 s46, 16
    s_mov_b32 s60, 1.0
    s_cselect_b32 s60, 0x3eb8aa3b, s60
    s_mov_b32 s61, s60
    s_mul_i32 s46, s38, 3
    s_add_u32 s46, s46, 2
    s_cmp_lt_u32 s46, 16
    s_mov_b32 s62, 1.0
    s_cselect_b32 s62, 0x3eb8aa3b, s62
    s_mov_b32 s63, s62
    v_lshlrev_b32 v228, 4, v0
    s_mul_i32 s46, s38, 3
    s_add_u32 s46, s46, 0
    s_lshr_b32 s47, s46, 4
    s_lshl_b32 s47, s47, 21
    s_and_b32 s48, s46, 15
    s_lshl_b32 s48, s48, 17
    s_add_u32 s47, s47, s48
    s_lshl_b32 s48, s37, 2
    s_add_u32 s48, s48, s3
    s_lshl_b32 s48, s48, 10
    s_add_u32 s54, s47, s48
    s_mul_i32 s46, s38, 3
    s_add_u32 s46, s46, 1
    s_lshr_b32 s47, s46, 4
    s_lshl_b32 s47, s47, 21
    s_and_b32 s48, s46, 15
    s_lshl_b32 s48, s48, 17
    s_add_u32 s47, s47, s48
    s_lshl_b32 s48, s37, 2
    s_add_u32 s48, s48, s3
    s_lshl_b32 s48, s48, 10
    s_add_u32 s55, s47, s48
    s_mul_i32 s46, s38, 3
    s_add_u32 s46, s46, 2
    s_lshr_b32 s47, s46, 4
    s_lshl_b32 s47, s47, 21
    s_and_b32 s48, s46, 15
    s_lshl_b32 s48, s48, 17
    s_add_u32 s47, s47, s48
    s_lshl_b32 s48, s37, 2
    s_add_u32 s48, s48, s3
    s_lshl_b32 s48, s48, 10
    s_add_u32 s56, s47, s48
    s_waitcnt lgkmcnt(0)
    s_mov_b32 s12, s4
    s_mov_b32 s13, s5
    s_mov_b32 s14, 0x200000
    s_mov_b32 s15, 0x20000
    s_mov_b32 s16, s6
    s_mov_b32 s17, s7
    s_mov_b32 s18, 0x180000
    s_mov_b32 s19, 0x20000
    s_mov_b32 s20, s8
    s_mov_b32 s21, s9
    s_mov_b32 s22, 0x1400000
    s_mov_b32 s23, 0x20000
    s_mov_b32 s28, s40
    s_mov_b32 s29, s41
    s_mov_b32 s30, 0x158000
    s_mov_b32 s31, 0x20000
    s_mov_b32 s24, s42
    s_mov_b32 s25, s43
    s_mov_b32 s26, 0xac0
    s_mov_b32 s27, 0x20000
    s_mov_b32 s32, s44
    s_mov_b32 s33, s45
    s_mov_b32 s34, 0x400
    s_mov_b32 s35, 0x20000
    v_mov_b32 v3, 0
    s_mov_b32 s46, 0xe46000
    buffer_load_dword v3, v3, s[20:23], s46 offen sc1
    v_lshlrev_b32 v1, 3, v2
    s_mul_i32 s51, s38, 192
    buffer_load_dwordx2 v[232:233], v1, s[24:27], s51 offen offset:0
    buffer_load_dwordx2 v[234:235], v1, s[24:27], s51 offen offset:16
    buffer_load_dwordx2 v[236:237], v1, s[24:27], s51 offen offset:32
    buffer_load_dwordx2 v[238:239], v1, s[24:27], s51 offen offset:48
    buffer_load_dwordx2 v[240:241], v1, s[24:27], s51 offen offset:64
    buffer_load_dwordx2 v[242:243], v1, s[24:27], s51 offen offset:80
    buffer_load_dwordx2 v[244:245], v1, s[24:27], s51 offen offset:96
    buffer_load_dwordx2 v[246:247], v1, s[24:27], s51 offen offset:112
    buffer_load_dwordx2 v[248:249], v1, s[24:27], s51 offen offset:128
    buffer_load_dwordx2 v[250:251], v1, s[24:27], s51 offen offset:144
    buffer_load_dwordx2 v[252:253], v1, s[24:27], s51 offen offset:160
    buffer_load_dwordx2 v[254:255], v1, s[24:27], s51 offen offset:176
    s_lshl_b32 s53, s37, 2
    s_add_u32 s53, s53, s3
    s_cmp_ge_u32 s38, 11
    s_cbranch_scc1 L_gated_mix__mha_block__dense_activation_squared_relu__prompt_kernel_qv7
    s_cmp_eq_u32 s38, 10
    s_cbranch_scc1 L_gated_mix__mha_block__dense_activation_squared_relu__prompt_kernel_qv4
    s_barrier
    ds_read_b128 v[100:103], v4 offset:0
    ds_read_b64_tr_b16 v[16:17], v229 offset:0
    ds_read_b64_tr_b16 v[18:19], v229 offset:768
    ds_read_b64_tr_b16 v[20:21], v229 offset:64
    ds_read_b64_tr_b16 v[22:23], v229 offset:832
    ds_read_b64_tr_b16 v[24:25], v229 offset:128
    ds_read_b64_tr_b16 v[26:27], v229 offset:896
    ds_read_b128 v[104:107], v5 offset:0
    ds_read_b64_tr_b16 v[28:29], v229 offset:3072
    ds_read_b64_tr_b16 v[30:31], v229 offset:3840
    ds_read_b64_tr_b16 v[32:33], v229 offset:3136
    ds_read_b64_tr_b16 v[34:35], v229 offset:3904
    ds_read_b64_tr_b16 v[36:37], v229 offset:3200
    ds_read_b64_tr_b16 v[38:39], v229 offset:3968
    s_waitcnt lgkmcnt(7)
    v_mfma_f32_32x32x16_bf16 v[52:67], v[16:19], v[100:103], 0
    ds_read_b128 v[108:111], v6 offset:0
    ds_read_b64_tr_b16 v[40:41], v229 offset:6144
    ds_read_b64_tr_b16 v[42:43], v229 offset:6912
    v_mfma_f32_32x32x16_bf16 v[68:83], v[20:23], v[100:103], 0
    ds_read_b64_tr_b16 v[44:45], v229 offset:6208
    ds_read_b64_tr_b16 v[46:47], v229 offset:6976
    v_mfma_f32_32x32x16_bf16 v[84:99], v[24:27], v[100:103], 0
    ds_read_b64_tr_b16 v[48:49], v229 offset:6272
    ds_read_b64_tr_b16 v[50:51], v229 offset:7040
    s_waitcnt lgkmcnt(7)
    v_mfma_f32_32x32x16_bf16 v[52:67], v[28:31], v[104:107], v[52:67]
    ds_read_b128 v[112:115], v7 offset:0
    ds_read_b64_tr_b16 v[16:17], v229 offset:9216
    ds_read_b64_tr_b16 v[18:19], v229 offset:9984
    v_mfma_f32_32x32x16_bf16 v[68:83], v[32:35], v[104:107], v[68:83]
    ds_read_b64_tr_b16 v[20:21], v229 offset:9280
    ds_read_b64_tr_b16 v[22:23], v229 offset:10048
    v_mfma_f32_32x32x16_bf16 v[84:99], v[36:39], v[104:107], v[84:99]
    ds_read_b64_tr_b16 v[24:25], v229 offset:9344
    ds_read_b64_tr_b16 v[26:27], v229 offset:10112
    s_waitcnt lgkmcnt(7)
    s_waitcnt lgkmcnt(0)
    s_barrier
    v_mfma_f32_32x32x16_bf16 v[52:67], v[40:43], v[108:111], v[52:67]
    ds_read_b128 v[116:119], v4 offset:28672
    ds_read_b64_tr_b16 v[28:29], v229 offset:28672
    ds_read_b64_tr_b16 v[30:31], v229 offset:29440
    v_mfma_f32_32x32x16_bf16 v[68:83], v[44:47], v[108:111], v[68:83]
    ds_read_b64_tr_b16 v[32:33], v229 offset:28736
    ds_read_b64_tr_b16 v[34:35], v229 offset:29504
    v_mfma_f32_32x32x16_bf16 v[84:99], v[48:51], v[108:111], v[84:99]
    ds_read_b64_tr_b16 v[36:37], v229 offset:28800
    ds_read_b64_tr_b16 v[38:39], v229 offset:29568
    v_mfma_f32_32x32x16_bf16 v[52:67], v[16:19], v[112:115], v[52:67]
    ds_read_b128 v[120:123], v5 offset:28672
    ds_read_b64_tr_b16 v[40:41], v229 offset:31744
    ds_read_b64_tr_b16 v[42:43], v229 offset:32512
    v_mfma_f32_32x32x16_bf16 v[68:83], v[20:23], v[112:115], v[68:83]
    ds_read_b64_tr_b16 v[44:45], v229 offset:31808
    ds_read_b64_tr_b16 v[46:47], v229 offset:32576
    v_mfma_f32_32x32x16_bf16 v[84:99], v[24:27], v[112:115], v[84:99]
    ds_read_b64_tr_b16 v[48:49], v229 offset:31872
    ds_read_b64_tr_b16 v[50:51], v229 offset:32640
    s_waitcnt lgkmcnt(7)
    v_mfma_f32_32x32x16_bf16 v[52:67], v[28:31], v[116:119], v[52:67]
    ds_read_b128 v[124:127], v6 offset:28672
    ds_read_b64_tr_b16 v[16:17], v229 offset:34816
    ds_read_b64_tr_b16 v[18:19], v229 offset:35584
    v_mfma_f32_32x32x16_bf16 v[68:83], v[32:35], v[116:119], v[68:83]
    ds_read_b64_tr_b16 v[20:21], v229 offset:34880
    ds_read_b64_tr_b16 v[22:23], v229 offset:35648
    v_mfma_f32_32x32x16_bf16 v[84:99], v[36:39], v[116:119], v[84:99]
    ds_read_b64_tr_b16 v[24:25], v229 offset:34944
    ds_read_b64_tr_b16 v[26:27], v229 offset:35712
    s_waitcnt lgkmcnt(7)
    v_mfma_f32_32x32x16_bf16 v[52:67], v[40:43], v[120:123], v[52:67]
    ds_read_b128 v[128:131], v7 offset:28672
    ds_read_b64_tr_b16 v[28:29], v229 offset:37888
    ds_read_b64_tr_b16 v[30:31], v229 offset:38656
    v_mfma_f32_32x32x16_bf16 v[68:83], v[44:47], v[120:123], v[68:83]
    ds_read_b64_tr_b16 v[32:33], v229 offset:37952
    ds_read_b64_tr_b16 v[34:35], v229 offset:38720
    v_mfma_f32_32x32x16_bf16 v[84:99], v[48:51], v[120:123], v[84:99]
    ds_read_b64_tr_b16 v[36:37], v229 offset:38016
    ds_read_b64_tr_b16 v[38:39], v229 offset:38784
    s_waitcnt lgkmcnt(7)
    s_waitcnt lgkmcnt(0)
    s_barrier
    v_mfma_f32_32x32x16_bf16 v[52:67], v[16:19], v[124:127], v[52:67]
    ds_read_b128 v[132:135], v8 offset:0
    ds_read_b64_tr_b16 v[40:41], v230 offset:0
    ds_read_b64_tr_b16 v[42:43], v230 offset:768
    v_mfma_f32_32x32x16_bf16 v[68:83], v[20:23], v[124:127], v[68:83]
    ds_read_b64_tr_b16 v[44:45], v230 offset:64
    ds_read_b64_tr_b16 v[46:47], v230 offset:832
    v_mfma_f32_32x32x16_bf16 v[84:99], v[24:27], v[124:127], v[84:99]
    ds_read_b64_tr_b16 v[48:49], v230 offset:128
    ds_read_b64_tr_b16 v[50:51], v230 offset:896
    v_mfma_f32_32x32x16_bf16 v[52:67], v[28:31], v[128:131], v[52:67]
    ds_read_b128 v[136:139], v9 offset:0
    ds_read_b64_tr_b16 v[16:17], v230 offset:3072
    ds_read_b64_tr_b16 v[18:19], v230 offset:3840
    v_mfma_f32_32x32x16_bf16 v[68:83], v[32:35], v[128:131], v[68:83]
    ds_read_b64_tr_b16 v[20:21], v230 offset:3136
    ds_read_b64_tr_b16 v[22:23], v230 offset:3904
    v_mfma_f32_32x32x16_bf16 v[84:99], v[36:39], v[128:131], v[84:99]
    ds_read_b64_tr_b16 v[24:25], v230 offset:3200
    ds_read_b64_tr_b16 v[26:27], v230 offset:3968
    s_waitcnt lgkmcnt(7)
    v_mfma_f32_32x32x16_bf16 v[52:67], v[40:43], v[132:135], v[52:67]
    ds_read_b128 v[140:143], v10 offset:0
    ds_read_b64_tr_b16 v[28:29], v230 offset:6144
    ds_read_b64_tr_b16 v[30:31], v230 offset:6912
    v_mfma_f32_32x32x16_bf16 v[68:83], v[44:47], v[132:135], v[68:83]
    ds_read_b64_tr_b16 v[32:33], v230 offset:6208
    ds_read_b64_tr_b16 v[34:35], v230 offset:6976
    v_mfma_f32_32x32x16_bf16 v[84:99], v[48:51], v[132:135], v[84:99]
    ds_read_b64_tr_b16 v[36:37], v230 offset:6272
    ds_read_b64_tr_b16 v[38:39], v230 offset:7040
    s_waitcnt lgkmcnt(7)
    v_mfma_f32_32x32x16_bf16 v[52:67], v[16:19], v[136:139], v[52:67]
    ds_read_b128 v[144:147], v11 offset:0
    ds_read_b64_tr_b16 v[40:41], v230 offset:9216
    ds_read_b64_tr_b16 v[42:43], v230 offset:9984
    v_mfma_f32_32x32x16_bf16 v[68:83], v[20:23], v[136:139], v[68:83]
    ds_read_b64_tr_b16 v[44:45], v230 offset:9280
    ds_read_b64_tr_b16 v[46:47], v230 offset:10048
    v_mfma_f32_32x32x16_bf16 v[84:99], v[24:27], v[136:139], v[84:99]
    ds_read_b64_tr_b16 v[48:49], v230 offset:9344
    ds_read_b64_tr_b16 v[50:51], v230 offset:10112
    s_waitcnt lgkmcnt(7)
    s_waitcnt lgkmcnt(0)
    s_barrier
    v_mfma_f32_32x32x16_bf16 v[52:67], v[28:31], v[140:143], v[52:67]
    ds_read_b128 v[148:151], v8 offset:28672
    ds_read_b64_tr_b16 v[16:17], v230 offset:28672
    ds_read_b64_tr_b16 v[18:19], v230 offset:29440
    v_mfma_f32_32x32x16_bf16 v[68:83], v[32:35], v[140:143], v[68:83]
    ds_read_b64_tr_b16 v[20:21], v230 offset:28736
    ds_read_b64_tr_b16 v[22:23], v230 offset:29504
    v_mfma_f32_32x32x16_bf16 v[84:99], v[36:39], v[140:143], v[84:99]
    ds_read_b64_tr_b16 v[24:25], v230 offset:28800
    ds_read_b64_tr_b16 v[26:27], v230 offset:29568
    v_mfma_f32_32x32x16_bf16 v[52:67], v[40:43], v[144:147], v[52:67]
    ds_read_b128 v[152:155], v9 offset:28672
    ds_read_b64_tr_b16 v[28:29], v230 offset:31744
    ds_read_b64_tr_b16 v[30:31], v230 offset:32512
    v_mfma_f32_32x32x16_bf16 v[68:83], v[44:47], v[144:147], v[68:83]
    ds_read_b64_tr_b16 v[32:33], v230 offset:31808
    ds_read_b64_tr_b16 v[34:35], v230 offset:32576
    v_mfma_f32_32x32x16_bf16 v[84:99], v[48:51], v[144:147], v[84:99]
    ds_read_b64_tr_b16 v[36:37], v230 offset:31872
    ds_read_b64_tr_b16 v[38:39], v230 offset:32640
    s_waitcnt lgkmcnt(7)
    v_mfma_f32_32x32x16_bf16 v[52:67], v[16:19], v[148:151], v[52:67]
    ds_read_b128 v[156:159], v10 offset:28672
    ds_read_b64_tr_b16 v[40:41], v230 offset:34816
    ds_read_b64_tr_b16 v[42:43], v230 offset:35584
    v_mfma_f32_32x32x16_bf16 v[68:83], v[20:23], v[148:151], v[68:83]
    ds_read_b64_tr_b16 v[44:45], v230 offset:34880
    ds_read_b64_tr_b16 v[46:47], v230 offset:35648
    v_mfma_f32_32x32x16_bf16 v[84:99], v[24:27], v[148:151], v[84:99]
    ds_read_b64_tr_b16 v[48:49], v230 offset:34944
    ds_read_b64_tr_b16 v[50:51], v230 offset:35712
    s_waitcnt lgkmcnt(7)
    v_mfma_f32_32x32x16_bf16 v[52:67], v[28:31], v[152:155], v[52:67]
    ds_read_b128 v[160:163], v11 offset:28672
    ds_read_b64_tr_b16 v[16:17], v230 offset:37888
    ds_read_b64_tr_b16 v[18:19], v230 offset:38656
    v_mfma_f32_32x32x16_bf16 v[68:83], v[32:35], v[152:155], v[68:83]
    ds_read_b64_tr_b16 v[20:21], v230 offset:37952
    ds_read_b64_tr_b16 v[22:23], v230 offset:38720
    v_mfma_f32_32x32x16_bf16 v[84:99], v[36:39], v[152:155], v[84:99]
    ds_read_b64_tr_b16 v[24:25], v230 offset:38016
    ds_read_b64_tr_b16 v[26:27], v230 offset:38784
    s_waitcnt lgkmcnt(7)
    s_waitcnt lgkmcnt(0)
    s_barrier
    v_mfma_f32_32x32x16_bf16 v[52:67], v[40:43], v[156:159], v[52:67]
    ds_read_b128 v[164:167], v12 offset:0
    ds_read_b64_tr_b16 v[28:29], v231 offset:0
    ds_read_b64_tr_b16 v[30:31], v231 offset:768
    v_mfma_f32_32x32x16_bf16 v[68:83], v[44:47], v[156:159], v[68:83]
    ds_read_b64_tr_b16 v[32:33], v231 offset:64
    ds_read_b64_tr_b16 v[34:35], v231 offset:832
    v_mfma_f32_32x32x16_bf16 v[84:99], v[48:51], v[156:159], v[84:99]
    ds_read_b64_tr_b16 v[36:37], v231 offset:128
    ds_read_b64_tr_b16 v[38:39], v231 offset:896
    v_mfma_f32_32x32x16_bf16 v[52:67], v[16:19], v[160:163], v[52:67]
    ds_read_b128 v[168:171], v13 offset:0
    ds_read_b64_tr_b16 v[40:41], v231 offset:3072
    ds_read_b64_tr_b16 v[42:43], v231 offset:3840
    v_mfma_f32_32x32x16_bf16 v[68:83], v[20:23], v[160:163], v[68:83]
    ds_read_b64_tr_b16 v[44:45], v231 offset:3136
    ds_read_b64_tr_b16 v[46:47], v231 offset:3904
    v_mfma_f32_32x32x16_bf16 v[84:99], v[24:27], v[160:163], v[84:99]
    ds_read_b64_tr_b16 v[48:49], v231 offset:3200
    ds_read_b64_tr_b16 v[50:51], v231 offset:3968
    s_waitcnt lgkmcnt(7)
    v_mfma_f32_32x32x16_bf16 v[52:67], v[28:31], v[164:167], v[52:67]
    ds_read_b128 v[172:175], v14 offset:0
    ds_read_b64_tr_b16 v[16:17], v231 offset:6144
    ds_read_b64_tr_b16 v[18:19], v231 offset:6912
    v_mfma_f32_32x32x16_bf16 v[68:83], v[32:35], v[164:167], v[68:83]
    ds_read_b64_tr_b16 v[20:21], v231 offset:6208
    ds_read_b64_tr_b16 v[22:23], v231 offset:6976
    v_mfma_f32_32x32x16_bf16 v[84:99], v[36:39], v[164:167], v[84:99]
    ds_read_b64_tr_b16 v[24:25], v231 offset:6272
    ds_read_b64_tr_b16 v[26:27], v231 offset:7040
    s_waitcnt lgkmcnt(7)
    v_mfma_f32_32x32x16_bf16 v[52:67], v[40:43], v[168:171], v[52:67]
    ds_read_b128 v[176:179], v15 offset:0
    ds_read_b64_tr_b16 v[28:29], v231 offset:9216
    ds_read_b64_tr_b16 v[30:31], v231 offset:9984
    v_mfma_f32_32x32x16_bf16 v[68:83], v[44:47], v[168:171], v[68:83]
    ds_read_b64_tr_b16 v[32:33], v231 offset:9280
    ds_read_b64_tr_b16 v[34:35], v231 offset:10048
    v_mfma_f32_32x32x16_bf16 v[84:99], v[48:51], v[168:171], v[84:99]
    ds_read_b64_tr_b16 v[36:37], v231 offset:9344
    ds_read_b64_tr_b16 v[38:39], v231 offset:10112
    s_waitcnt lgkmcnt(7)
    s_waitcnt lgkmcnt(0)
    s_barrier
    v_mfma_f32_32x32x16_bf16 v[52:67], v[16:19], v[172:175], v[52:67]
    ds_read_b128 v[180:183], v4 offset:0
    ds_read_b64_tr_b16 v[40:41], v229 offset:0
    ds_read_b64_tr_b16 v[42:43], v229 offset:768
    v_mfma_f32_32x32x16_bf16 v[68:83], v[20:23], v[172:175], v[68:83]
    ds_read_b64_tr_b16 v[44:45], v229 offset:64
    ds_read_b64_tr_b16 v[46:47], v229 offset:832
    v_mfma_f32_32x32x16_bf16 v[84:99], v[24:27], v[172:175], v[84:99]
    ds_read_b64_tr_b16 v[48:49], v229 offset:128
    ds_read_b64_tr_b16 v[50:51], v229 offset:896
    v_mfma_f32_32x32x16_bf16 v[52:67], v[28:31], v[176:179], v[52:67]
    ds_read_b128 v[184:187], v5 offset:0
    ds_read_b64_tr_b16 v[16:17], v229 offset:3072
    ds_read_b64_tr_b16 v[18:19], v229 offset:3840
    v_mfma_f32_32x32x16_bf16 v[68:83], v[32:35], v[176:179], v[68:83]
    ds_read_b64_tr_b16 v[20:21], v229 offset:3136
    ds_read_b64_tr_b16 v[22:23], v229 offset:3904
    v_mfma_f32_32x32x16_bf16 v[84:99], v[36:39], v[176:179], v[84:99]
    ds_read_b64_tr_b16 v[24:25], v229 offset:3200
    ds_read_b64_tr_b16 v[26:27], v229 offset:3968
    s_waitcnt lgkmcnt(7)
    v_mfma_f32_32x32x16_bf16 v[52:67], v[40:43], v[180:183], v[52:67]
    ds_read_b128 v[188:191], v6 offset:0
    ds_read_b64_tr_b16 v[28:29], v229 offset:6144
    ds_read_b64_tr_b16 v[30:31], v229 offset:6912
    v_mfma_f32_32x32x16_bf16 v[68:83], v[44:47], v[180:183], v[68:83]
    ds_read_b64_tr_b16 v[32:33], v229 offset:6208
    ds_read_b64_tr_b16 v[34:35], v229 offset:6976
    v_mfma_f32_32x32x16_bf16 v[84:99], v[48:51], v[180:183], v[84:99]
    ds_read_b64_tr_b16 v[36:37], v229 offset:6272
    ds_read_b64_tr_b16 v[38:39], v229 offset:7040
    s_waitcnt lgkmcnt(7)
    v_mfma_f32_32x32x16_bf16 v[52:67], v[16:19], v[184:187], v[52:67]
    ds_read_b128 v[192:195], v7 offset:0
    ds_read_b64_tr_b16 v[40:41], v229 offset:9216
    ds_read_b64_tr_b16 v[42:43], v229 offset:9984
    v_mfma_f32_32x32x16_bf16 v[68:83], v[20:23], v[184:187], v[68:83]
    ds_read_b64_tr_b16 v[44:45], v229 offset:9280
    ds_read_b64_tr_b16 v[46:47], v229 offset:10048
    v_mfma_f32_32x32x16_bf16 v[84:99], v[24:27], v[184:187], v[84:99]
    ds_read_b64_tr_b16 v[48:49], v229 offset:9344
    ds_read_b64_tr_b16 v[50:51], v229 offset:10112
    s_waitcnt lgkmcnt(7)
    s_waitcnt lgkmcnt(0)
    s_barrier
    v_mfma_f32_32x32x16_bf16 v[52:67], v[28:31], v[188:191], v[52:67]
    ds_read_b128 v[196:199], v4 offset:28672
    ds_read_b64_tr_b16 v[16:17], v229 offset:28672
    ds_read_b64_tr_b16 v[18:19], v229 offset:29440
    v_mfma_f32_32x32x16_bf16 v[68:83], v[32:35], v[188:191], v[68:83]
    ds_read_b64_tr_b16 v[20:21], v229 offset:28736
    ds_read_b64_tr_b16 v[22:23], v229 offset:29504
    v_mfma_f32_32x32x16_bf16 v[84:99], v[36:39], v[188:191], v[84:99]
    ds_read_b64_tr_b16 v[24:25], v229 offset:28800
    ds_read_b64_tr_b16 v[26:27], v229 offset:29568
    v_mfma_f32_32x32x16_bf16 v[52:67], v[40:43], v[192:195], v[52:67]
    ds_read_b128 v[200:203], v5 offset:28672
    ds_read_b64_tr_b16 v[28:29], v229 offset:31744
    ds_read_b64_tr_b16 v[30:31], v229 offset:32512
    v_mfma_f32_32x32x16_bf16 v[68:83], v[44:47], v[192:195], v[68:83]
    ds_read_b64_tr_b16 v[32:33], v229 offset:31808
    ds_read_b64_tr_b16 v[34:35], v229 offset:32576
    v_mfma_f32_32x32x16_bf16 v[84:99], v[48:51], v[192:195], v[84:99]
    ds_read_b64_tr_b16 v[36:37], v229 offset:31872
    ds_read_b64_tr_b16 v[38:39], v229 offset:32640
    s_waitcnt lgkmcnt(7)
    v_mfma_f32_32x32x16_bf16 v[52:67], v[16:19], v[196:199], v[52:67]
    ds_read_b128 v[204:207], v6 offset:28672
    ds_read_b64_tr_b16 v[40:41], v229 offset:34816
    ds_read_b64_tr_b16 v[42:43], v229 offset:35584
    v_mfma_f32_32x32x16_bf16 v[68:83], v[20:23], v[196:199], v[68:83]
    ds_read_b64_tr_b16 v[44:45], v229 offset:34880
    ds_read_b64_tr_b16 v[46:47], v229 offset:35648
    v_mfma_f32_32x32x16_bf16 v[84:99], v[24:27], v[196:199], v[84:99]
    ds_read_b64_tr_b16 v[48:49], v229 offset:34944
    ds_read_b64_tr_b16 v[50:51], v229 offset:35712
    s_waitcnt lgkmcnt(7)
    v_mfma_f32_32x32x16_bf16 v[52:67], v[28:31], v[200:203], v[52:67]
    ds_read_b128 v[208:211], v7 offset:28672
    ds_read_b64_tr_b16 v[16:17], v229 offset:37888
    ds_read_b64_tr_b16 v[18:19], v229 offset:38656
    v_mfma_f32_32x32x16_bf16 v[68:83], v[32:35], v[200:203], v[68:83]
    ds_read_b64_tr_b16 v[20:21], v229 offset:37952
    ds_read_b64_tr_b16 v[22:23], v229 offset:38720
    v_mfma_f32_32x32x16_bf16 v[84:99], v[36:39], v[200:203], v[84:99]
    ds_read_b64_tr_b16 v[24:25], v229 offset:38016
    ds_read_b64_tr_b16 v[26:27], v229 offset:38784
    s_waitcnt lgkmcnt(7)
    s_waitcnt lgkmcnt(0)
    s_barrier
    v_mfma_f32_32x32x16_bf16 v[52:67], v[40:43], v[204:207], v[52:67]
    ds_read_b128 v[212:215], v8 offset:0
    ds_read_b64_tr_b16 v[28:29], v230 offset:0
    ds_read_b64_tr_b16 v[30:31], v230 offset:768
    v_mfma_f32_32x32x16_bf16 v[68:83], v[44:47], v[204:207], v[68:83]
    ds_read_b64_tr_b16 v[32:33], v230 offset:64
    ds_read_b64_tr_b16 v[34:35], v230 offset:832
    v_mfma_f32_32x32x16_bf16 v[84:99], v[48:51], v[204:207], v[84:99]
    ds_read_b64_tr_b16 v[36:37], v230 offset:128
    ds_read_b64_tr_b16 v[38:39], v230 offset:896
    v_mfma_f32_32x32x16_bf16 v[52:67], v[16:19], v[208:211], v[52:67]
    ds_read_b128 v[216:219], v9 offset:0
    ds_read_b64_tr_b16 v[40:41], v230 offset:3072
    ds_read_b64_tr_b16 v[42:43], v230 offset:3840
    v_mfma_f32_32x32x16_bf16 v[68:83], v[20:23], v[208:211], v[68:83]
    ds_read_b64_tr_b16 v[44:45], v230 offset:3136
    ds_read_b64_tr_b16 v[46:47], v230 offset:3904
    v_mfma_f32_32x32x16_bf16 v[84:99], v[24:27], v[208:211], v[84:99]
    ds_read_b64_tr_b16 v[48:49], v230 offset:3200
    ds_read_b64_tr_b16 v[50:51], v230 offset:3968
    s_waitcnt lgkmcnt(7)
    v_mfma_f32_32x32x16_bf16 v[52:67], v[28:31], v[212:215], v[52:67]
    ds_read_b128 v[220:223], v10 offset:0
    ds_read_b64_tr_b16 v[16:17], v230 offset:6144
    ds_read_b64_tr_b16 v[18:19], v230 offset:6912
    v_mfma_f32_32x32x16_bf16 v[68:83], v[32:35], v[212:215], v[68:83]
    ds_read_b64_tr_b16 v[20:21], v230 offset:6208
    ds_read_b64_tr_b16 v[22:23], v230 offset:6976
    v_mfma_f32_32x32x16_bf16 v[84:99], v[36:39], v[212:215], v[84:99]
    ds_read_b64_tr_b16 v[24:25], v230 offset:6272
    ds_read_b64_tr_b16 v[26:27], v230 offset:7040
    s_waitcnt lgkmcnt(7)
    v_mfma_f32_32x32x16_bf16 v[52:67], v[40:43], v[216:219], v[52:67]
    ds_read_b128 v[224:227], v11 offset:0
    ds_read_b64_tr_b16 v[28:29], v230 offset:9216
    ds_read_b64_tr_b16 v[30:31], v230 offset:9984
    v_mfma_f32_32x32x16_bf16 v[68:83], v[44:47], v[216:219], v[68:83]
    ds_read_b64_tr_b16 v[32:33], v230 offset:9280
    ds_read_b64_tr_b16 v[34:35], v230 offset:10048
    v_mfma_f32_32x32x16_bf16 v[84:99], v[48:51], v[216:219], v[84:99]
    ds_read_b64_tr_b16 v[36:37], v230 offset:9344
    ds_read_b64_tr_b16 v[38:39], v230 offset:10112
    s_waitcnt lgkmcnt(7)
    v_mfma_f32_32x32x16_bf16 v[52:67], v[16:19], v[220:223], v[52:67]
    v_mfma_f32_32x32x16_bf16 v[68:83], v[20:23], v[220:223], v[68:83]
    v_mfma_f32_32x32x16_bf16 v[84:99], v[24:27], v[220:223], v[84:99]
    s_waitcnt lgkmcnt(0)
    v_mfma_f32_32x32x16_bf16 v[52:67], v[28:31], v[224:227], v[52:67]
    v_mfma_f32_32x32x16_bf16 v[68:83], v[32:35], v[224:227], v[68:83]
    v_mfma_f32_32x32x16_bf16 v[84:99], v[36:39], v[224:227], v[84:99]
    s_nop 15
    v_pk_mul_f32 v[52:53], v[52:53], s[58:59]
    v_pk_mul_f32 v[54:55], v[54:55], s[58:59]
    v_pk_mul_f32 v[56:57], v[56:57], s[58:59]
    v_pk_mul_f32 v[58:59], v[58:59], s[58:59]
    v_pk_mul_f32 v[60:61], v[60:61], s[58:59]
    v_pk_mul_f32 v[62:63], v[62:63], s[58:59]
    v_pk_mul_f32 v[64:65], v[64:65], s[58:59]
    v_pk_mul_f32 v[66:67], v[66:67], s[58:59]
    v_cvt_pk_bf16_f32 v52, v52, v53
    v_cvt_pk_bf16_f32 v53, v54, v55
    v_cvt_pk_bf16_f32 v54, v56, v57
    v_cvt_pk_bf16_f32 v55, v58, v59
    buffer_store_dwordx4 v[52:55], v228, s[20:23], s54 offen sc1
    v_cvt_pk_bf16_f32 v60, v60, v61
    v_cvt_pk_bf16_f32 v61, v62, v63
    v_cvt_pk_bf16_f32 v62, v64, v65
    v_cvt_pk_bf16_f32 v63, v66, v67
    s_add_u32 s46, s54, 65536
    buffer_store_dwordx4 v[60:63], v228, s[20:23], s46 offen sc1
    v_pk_mul_f32 v[68:69], v[68:69], s[60:61]
    v_pk_mul_f32 v[70:71], v[70:71], s[60:61]
    v_pk_mul_f32 v[72:73], v[72:73], s[60:61]
    v_pk_mul_f32 v[74:75], v[74:75], s[60:61]
    v_pk_mul_f32 v[76:77], v[76:77], s[60:61]
    v_pk_mul_f32 v[78:79], v[78:79], s[60:61]
    v_pk_mul_f32 v[80:81], v[80:81], s[60:61]
    v_pk_mul_f32 v[82:83], v[82:83], s[60:61]
    v_cvt_pk_bf16_f32 v68, v68, v69
    v_cvt_pk_bf16_f32 v69, v70, v71
    v_cvt_pk_bf16_f32 v70, v72, v73
    v_cvt_pk_bf16_f32 v71, v74, v75
    buffer_store_dwordx4 v[68:71], v228, s[20:23], s55 offen sc1
    v_cvt_pk_bf16_f32 v76, v76, v77
    v_cvt_pk_bf16_f32 v77, v78, v79
    v_cvt_pk_bf16_f32 v78, v80, v81
    v_cvt_pk_bf16_f32 v79, v82, v83
    s_add_u32 s46, s55, 65536
    buffer_store_dwordx4 v[76:79], v228, s[20:23], s46 offen sc1
    v_pk_mul_f32 v[84:85], v[84:85], s[62:63]
    v_pk_mul_f32 v[86:87], v[86:87], s[62:63]
    v_pk_mul_f32 v[88:89], v[88:89], s[62:63]
    v_pk_mul_f32 v[90:91], v[90:91], s[62:63]
    v_pk_mul_f32 v[92:93], v[92:93], s[62:63]
    v_pk_mul_f32 v[94:95], v[94:95], s[62:63]
    v_pk_mul_f32 v[96:97], v[96:97], s[62:63]
    v_pk_mul_f32 v[98:99], v[98:99], s[62:63]
    v_cvt_pk_bf16_f32 v84, v84, v85
    v_cvt_pk_bf16_f32 v85, v86, v87
    v_cvt_pk_bf16_f32 v86, v88, v89
    v_cvt_pk_bf16_f32 v87, v90, v91
    buffer_store_dwordx4 v[84:87], v228, s[20:23], s56 offen sc1
    v_cvt_pk_bf16_f32 v92, v92, v93
    v_cvt_pk_bf16_f32 v93, v94, v95
    v_cvt_pk_bf16_f32 v94, v96, v97
    v_cvt_pk_bf16_f32 v95, v98, v99
    s_add_u32 s46, s56, 65536
    buffer_store_dwordx4 v[92:95], v228, s[20:23], s46 offen sc1
    s_branch L_gated_mix__mha_block__dense_activation_squared_relu__prompt_kernel_qdone
L_gated_mix__mha_block__dense_activation_squared_relu__prompt_kernel_qv4:
    s_barrier
    ds_read_b128 v[100:103], v4 offset:0
    ds_read_b64_tr_b16 v[16:17], v229 offset:0
    ds_read_b64_tr_b16 v[18:19], v229 offset:768
    ds_read_b64_tr_b16 v[20:21], v229 offset:64
    ds_read_b64_tr_b16 v[22:23], v229 offset:832
    ds_read_b64_tr_b16 v[24:25], v229 offset:128
    ds_read_b64_tr_b16 v[26:27], v229 offset:896
    ds_read_b128 v[104:107], v5 offset:0
    ds_read_b64_tr_b16 v[28:29], v229 offset:3072
    ds_read_b64_tr_b16 v[30:31], v229 offset:3840
    ds_read_b64_tr_b16 v[32:33], v229 offset:3136
    ds_read_b64_tr_b16 v[34:35], v229 offset:3904
    ds_read_b64_tr_b16 v[36:37], v229 offset:3200
    ds_read_b64_tr_b16 v[38:39], v229 offset:3968
    s_waitcnt lgkmcnt(7)
    v_mfma_f32_32x32x16_bf16 v[52:67], v[16:19], v[100:103], 0
    ds_read_b128 v[108:111], v6 offset:0
    ds_read_b64_tr_b16 v[40:41], v229 offset:6144
    ds_read_b64_tr_b16 v[42:43], v229 offset:6912
    v_mfma_f32_32x32x16_bf16 v[68:83], v[20:23], v[100:103], 0
    ds_read_b64_tr_b16 v[44:45], v229 offset:6208
    ds_read_b64_tr_b16 v[46:47], v229 offset:6976
    v_mfma_f32_32x32x16_bf16 v[84:99], v[100:103], v[24:27], 0
    ds_read_b64_tr_b16 v[48:49], v229 offset:6272
    ds_read_b64_tr_b16 v[50:51], v229 offset:7040
    s_waitcnt lgkmcnt(7)
    v_mfma_f32_32x32x16_bf16 v[52:67], v[28:31], v[104:107], v[52:67]
    ds_read_b128 v[112:115], v7 offset:0
    ds_read_b64_tr_b16 v[16:17], v229 offset:9216
    ds_read_b64_tr_b16 v[18:19], v229 offset:9984
    v_mfma_f32_32x32x16_bf16 v[68:83], v[32:35], v[104:107], v[68:83]
    ds_read_b64_tr_b16 v[20:21], v229 offset:9280
    ds_read_b64_tr_b16 v[22:23], v229 offset:10048
    v_mfma_f32_32x32x16_bf16 v[84:99], v[104:107], v[36:39], v[84:99]
    ds_read_b64_tr_b16 v[24:25], v229 offset:9344
    ds_read_b64_tr_b16 v[26:27], v229 offset:10112
    s_waitcnt lgkmcnt(7)
    s_waitcnt lgkmcnt(0)
    s_barrier
    v_mfma_f32_32x32x16_bf16 v[52:67], v[40:43], v[108:111], v[52:67]
    ds_read_b128 v[116:119], v4 offset:28672
    ds_read_b64_tr_b16 v[28:29], v229 offset:28672
    ds_read_b64_tr_b16 v[30:31], v229 offset:29440
    v_mfma_f32_32x32x16_bf16 v[68:83], v[44:47], v[108:111], v[68:83]
    ds_read_b64_tr_b16 v[32:33], v229 offset:28736
    ds_read_b64_tr_b16 v[34:35], v229 offset:29504
    v_mfma_f32_32x32x16_bf16 v[84:99], v[108:111], v[48:51], v[84:99]
    ds_read_b64_tr_b16 v[36:37], v229 offset:28800
    ds_read_b64_tr_b16 v[38:39], v229 offset:29568
    v_mfma_f32_32x32x16_bf16 v[52:67], v[16:19], v[112:115], v[52:67]
    ds_read_b128 v[120:123], v5 offset:28672
    ds_read_b64_tr_b16 v[40:41], v229 offset:31744
    ds_read_b64_tr_b16 v[42:43], v229 offset:32512
    v_mfma_f32_32x32x16_bf16 v[68:83], v[20:23], v[112:115], v[68:83]
    ds_read_b64_tr_b16 v[44:45], v229 offset:31808
    ds_read_b64_tr_b16 v[46:47], v229 offset:32576
    v_mfma_f32_32x32x16_bf16 v[84:99], v[112:115], v[24:27], v[84:99]
    ds_read_b64_tr_b16 v[48:49], v229 offset:31872
    ds_read_b64_tr_b16 v[50:51], v229 offset:32640
    s_waitcnt lgkmcnt(7)
    v_mfma_f32_32x32x16_bf16 v[52:67], v[28:31], v[116:119], v[52:67]
    ds_read_b128 v[124:127], v6 offset:28672
    ds_read_b64_tr_b16 v[16:17], v229 offset:34816
    ds_read_b64_tr_b16 v[18:19], v229 offset:35584
    v_mfma_f32_32x32x16_bf16 v[68:83], v[32:35], v[116:119], v[68:83]
    ds_read_b64_tr_b16 v[20:21], v229 offset:34880
    ds_read_b64_tr_b16 v[22:23], v229 offset:35648
    v_mfma_f32_32x32x16_bf16 v[84:99], v[116:119], v[36:39], v[84:99]
    ds_read_b64_tr_b16 v[24:25], v229 offset:34944
    ds_read_b64_tr_b16 v[26:27], v229 offset:35712
    s_waitcnt lgkmcnt(7)
    v_mfma_f32_32x32x16_bf16 v[52:67], v[40:43], v[120:123], v[52:67]
    ds_read_b128 v[128:131], v7 offset:28672
    ds_read_b64_tr_b16 v[28:29], v229 offset:37888
    ds_read_b64_tr_b16 v[30:31], v229 offset:38656
    v_mfma_f32_32x32x16_bf16 v[68:83], v[44:47], v[120:123], v[68:83]
    ds_read_b64_tr_b16 v[32:33], v229 offset:37952
    ds_read_b64_tr_b16 v[34:35], v229 offset:38720
    v_mfma_f32_32x32x16_bf16 v[84:99], v[120:123], v[48:51], v[84:99]
    ds_read_b64_tr_b16 v[36:37], v229 offset:38016
    ds_read_b64_tr_b16 v[38:39], v229 offset:38784
    s_waitcnt lgkmcnt(7)
    s_waitcnt lgkmcnt(0)
    s_barrier
    v_mfma_f32_32x32x16_bf16 v[52:67], v[16:19], v[124:127], v[52:67]
    ds_read_b128 v[132:135], v8 offset:0
    ds_read_b64_tr_b16 v[40:41], v230 offset:0
    ds_read_b64_tr_b16 v[42:43], v230 offset:768
    v_mfma_f32_32x32x16_bf16 v[68:83], v[20:23], v[124:127], v[68:83]
    ds_read_b64_tr_b16 v[44:45], v230 offset:64
    ds_read_b64_tr_b16 v[46:47], v230 offset:832
    v_mfma_f32_32x32x16_bf16 v[84:99], v[124:127], v[24:27], v[84:99]
    ds_read_b64_tr_b16 v[48:49], v230 offset:128
    ds_read_b64_tr_b16 v[50:51], v230 offset:896
    v_mfma_f32_32x32x16_bf16 v[52:67], v[28:31], v[128:131], v[52:67]
    ds_read_b128 v[136:139], v9 offset:0
    ds_read_b64_tr_b16 v[16:17], v230 offset:3072
    ds_read_b64_tr_b16 v[18:19], v230 offset:3840
    v_mfma_f32_32x32x16_bf16 v[68:83], v[32:35], v[128:131], v[68:83]
    ds_read_b64_tr_b16 v[20:21], v230 offset:3136
    ds_read_b64_tr_b16 v[22:23], v230 offset:3904
    v_mfma_f32_32x32x16_bf16 v[84:99], v[128:131], v[36:39], v[84:99]
    ds_read_b64_tr_b16 v[24:25], v230 offset:3200
    ds_read_b64_tr_b16 v[26:27], v230 offset:3968
    s_waitcnt lgkmcnt(7)
    v_mfma_f32_32x32x16_bf16 v[52:67], v[40:43], v[132:135], v[52:67]
    ds_read_b128 v[140:143], v10 offset:0
    ds_read_b64_tr_b16 v[28:29], v230 offset:6144
    ds_read_b64_tr_b16 v[30:31], v230 offset:6912
    v_mfma_f32_32x32x16_bf16 v[68:83], v[44:47], v[132:135], v[68:83]
    ds_read_b64_tr_b16 v[32:33], v230 offset:6208
    ds_read_b64_tr_b16 v[34:35], v230 offset:6976
    v_mfma_f32_32x32x16_bf16 v[84:99], v[132:135], v[48:51], v[84:99]
    ds_read_b64_tr_b16 v[36:37], v230 offset:6272
    ds_read_b64_tr_b16 v[38:39], v230 offset:7040
    s_waitcnt lgkmcnt(7)
    v_mfma_f32_32x32x16_bf16 v[52:67], v[16:19], v[136:139], v[52:67]
    ds_read_b128 v[144:147], v11 offset:0
    ds_read_b64_tr_b16 v[40:41], v230 offset:9216
    ds_read_b64_tr_b16 v[42:43], v230 offset:9984
    v_mfma_f32_32x32x16_bf16 v[68:83], v[20:23], v[136:139], v[68:83]
    ds_read_b64_tr_b16 v[44:45], v230 offset:9280
    ds_read_b64_tr_b16 v[46:47], v230 offset:10048
    v_mfma_f32_32x32x16_bf16 v[84:99], v[136:139], v[24:27], v[84:99]
    ds_read_b64_tr_b16 v[48:49], v230 offset:9344
    ds_read_b64_tr_b16 v[50:51], v230 offset:10112
    s_waitcnt lgkmcnt(7)
    s_waitcnt lgkmcnt(0)
    s_barrier
    v_mfma_f32_32x32x16_bf16 v[52:67], v[28:31], v[140:143], v[52:67]
    ds_read_b128 v[148:151], v8 offset:28672
    ds_read_b64_tr_b16 v[16:17], v230 offset:28672
    ds_read_b64_tr_b16 v[18:19], v230 offset:29440
    v_mfma_f32_32x32x16_bf16 v[68:83], v[32:35], v[140:143], v[68:83]
    ds_read_b64_tr_b16 v[20:21], v230 offset:28736
    ds_read_b64_tr_b16 v[22:23], v230 offset:29504
    v_mfma_f32_32x32x16_bf16 v[84:99], v[140:143], v[36:39], v[84:99]
    ds_read_b64_tr_b16 v[24:25], v230 offset:28800
    ds_read_b64_tr_b16 v[26:27], v230 offset:29568
    v_mfma_f32_32x32x16_bf16 v[52:67], v[40:43], v[144:147], v[52:67]
    ds_read_b128 v[152:155], v9 offset:28672
    ds_read_b64_tr_b16 v[28:29], v230 offset:31744
    ds_read_b64_tr_b16 v[30:31], v230 offset:32512
    v_mfma_f32_32x32x16_bf16 v[68:83], v[44:47], v[144:147], v[68:83]
    ds_read_b64_tr_b16 v[32:33], v230 offset:31808
    ds_read_b64_tr_b16 v[34:35], v230 offset:32576
    v_mfma_f32_32x32x16_bf16 v[84:99], v[144:147], v[48:51], v[84:99]
    ds_read_b64_tr_b16 v[36:37], v230 offset:31872
    ds_read_b64_tr_b16 v[38:39], v230 offset:32640
    s_waitcnt lgkmcnt(7)
    v_mfma_f32_32x32x16_bf16 v[52:67], v[16:19], v[148:151], v[52:67]
    ds_read_b128 v[156:159], v10 offset:28672
    ds_read_b64_tr_b16 v[40:41], v230 offset:34816
    ds_read_b64_tr_b16 v[42:43], v230 offset:35584
    v_mfma_f32_32x32x16_bf16 v[68:83], v[20:23], v[148:151], v[68:83]
    ds_read_b64_tr_b16 v[44:45], v230 offset:34880
    ds_read_b64_tr_b16 v[46:47], v230 offset:35648
    v_mfma_f32_32x32x16_bf16 v[84:99], v[148:151], v[24:27], v[84:99]
    ds_read_b64_tr_b16 v[48:49], v230 offset:34944
    ds_read_b64_tr_b16 v[50:51], v230 offset:35712
    s_waitcnt lgkmcnt(7)
    v_mfma_f32_32x32x16_bf16 v[52:67], v[28:31], v[152:155], v[52:67]
    ds_read_b128 v[160:163], v11 offset:28672
    ds_read_b64_tr_b16 v[16:17], v230 offset:37888
    ds_read_b64_tr_b16 v[18:19], v230 offset:38656
    v_mfma_f32_32x32x16_bf16 v[68:83], v[32:35], v[152:155], v[68:83]
    ds_read_b64_tr_b16 v[20:21], v230 offset:37952
    ds_read_b64_tr_b16 v[22:23], v230 offset:38720
    v_mfma_f32_32x32x16_bf16 v[84:99], v[152:155], v[36:39], v[84:99]
    ds_read_b64_tr_b16 v[24:25], v230 offset:38016
    ds_read_b64_tr_b16 v[26:27], v230 offset:38784
    s_waitcnt lgkmcnt(7)
    s_waitcnt lgkmcnt(0)
    s_barrier
    v_mfma_f32_32x32x16_bf16 v[52:67], v[40:43], v[156:159], v[52:67]
    ds_read_b128 v[164:167], v12 offset:0
    ds_read_b64_tr_b16 v[28:29], v231 offset:0
    ds_read_b64_tr_b16 v[30:31], v231 offset:768
    v_mfma_f32_32x32x16_bf16 v[68:83], v[44:47], v[156:159], v[68:83]
    ds_read_b64_tr_b16 v[32:33], v231 offset:64
    ds_read_b64_tr_b16 v[34:35], v231 offset:832
    v_mfma_f32_32x32x16_bf16 v[84:99], v[156:159], v[48:51], v[84:99]
    ds_read_b64_tr_b16 v[36:37], v231 offset:128
    ds_read_b64_tr_b16 v[38:39], v231 offset:896
    v_mfma_f32_32x32x16_bf16 v[52:67], v[16:19], v[160:163], v[52:67]
    ds_read_b128 v[168:171], v13 offset:0
    ds_read_b64_tr_b16 v[40:41], v231 offset:3072
    ds_read_b64_tr_b16 v[42:43], v231 offset:3840
    v_mfma_f32_32x32x16_bf16 v[68:83], v[20:23], v[160:163], v[68:83]
    ds_read_b64_tr_b16 v[44:45], v231 offset:3136
    ds_read_b64_tr_b16 v[46:47], v231 offset:3904
    v_mfma_f32_32x32x16_bf16 v[84:99], v[160:163], v[24:27], v[84:99]
    ds_read_b64_tr_b16 v[48:49], v231 offset:3200
    ds_read_b64_tr_b16 v[50:51], v231 offset:3968
    s_waitcnt lgkmcnt(7)
    v_mfma_f32_32x32x16_bf16 v[52:67], v[28:31], v[164:167], v[52:67]
    ds_read_b128 v[172:175], v14 offset:0
    ds_read_b64_tr_b16 v[16:17], v231 offset:6144
    ds_read_b64_tr_b16 v[18:19], v231 offset:6912
    v_mfma_f32_32x32x16_bf16 v[68:83], v[32:35], v[164:167], v[68:83]
    ds_read_b64_tr_b16 v[20:21], v231 offset:6208
    ds_read_b64_tr_b16 v[22:23], v231 offset:6976
    v_mfma_f32_32x32x16_bf16 v[84:99], v[164:167], v[36:39], v[84:99]
    ds_read_b64_tr_b16 v[24:25], v231 offset:6272
    ds_read_b64_tr_b16 v[26:27], v231 offset:7040
    s_waitcnt lgkmcnt(7)
    v_mfma_f32_32x32x16_bf16 v[52:67], v[40:43], v[168:171], v[52:67]
    ds_read_b128 v[176:179], v15 offset:0
    ds_read_b64_tr_b16 v[28:29], v231 offset:9216
    ds_read_b64_tr_b16 v[30:31], v231 offset:9984
    v_mfma_f32_32x32x16_bf16 v[68:83], v[44:47], v[168:171], v[68:83]
    ds_read_b64_tr_b16 v[32:33], v231 offset:9280
    ds_read_b64_tr_b16 v[34:35], v231 offset:10048
    v_mfma_f32_32x32x16_bf16 v[84:99], v[168:171], v[48:51], v[84:99]
    ds_read_b64_tr_b16 v[36:37], v231 offset:9344
    ds_read_b64_tr_b16 v[38:39], v231 offset:10112
    s_waitcnt lgkmcnt(7)
    s_waitcnt lgkmcnt(0)
    s_barrier
    v_mfma_f32_32x32x16_bf16 v[52:67], v[16:19], v[172:175], v[52:67]
    ds_read_b128 v[180:183], v4 offset:0
    ds_read_b64_tr_b16 v[40:41], v229 offset:0
    ds_read_b64_tr_b16 v[42:43], v229 offset:768
    v_mfma_f32_32x32x16_bf16 v[68:83], v[20:23], v[172:175], v[68:83]
    ds_read_b64_tr_b16 v[44:45], v229 offset:64
    ds_read_b64_tr_b16 v[46:47], v229 offset:832
    v_mfma_f32_32x32x16_bf16 v[84:99], v[172:175], v[24:27], v[84:99]
    ds_read_b64_tr_b16 v[48:49], v229 offset:128
    ds_read_b64_tr_b16 v[50:51], v229 offset:896
    v_mfma_f32_32x32x16_bf16 v[52:67], v[28:31], v[176:179], v[52:67]
    ds_read_b128 v[184:187], v5 offset:0
    ds_read_b64_tr_b16 v[16:17], v229 offset:3072
    ds_read_b64_tr_b16 v[18:19], v229 offset:3840
    v_mfma_f32_32x32x16_bf16 v[68:83], v[32:35], v[176:179], v[68:83]
    ds_read_b64_tr_b16 v[20:21], v229 offset:3136
    ds_read_b64_tr_b16 v[22:23], v229 offset:3904
    v_mfma_f32_32x32x16_bf16 v[84:99], v[176:179], v[36:39], v[84:99]
    ds_read_b64_tr_b16 v[24:25], v229 offset:3200
    ds_read_b64_tr_b16 v[26:27], v229 offset:3968
    s_waitcnt lgkmcnt(7)
    v_mfma_f32_32x32x16_bf16 v[52:67], v[40:43], v[180:183], v[52:67]
    ds_read_b128 v[188:191], v6 offset:0
    ds_read_b64_tr_b16 v[28:29], v229 offset:6144
    ds_read_b64_tr_b16 v[30:31], v229 offset:6912
    v_mfma_f32_32x32x16_bf16 v[68:83], v[44:47], v[180:183], v[68:83]
    ds_read_b64_tr_b16 v[32:33], v229 offset:6208
    ds_read_b64_tr_b16 v[34:35], v229 offset:6976
    v_mfma_f32_32x32x16_bf16 v[84:99], v[180:183], v[48:51], v[84:99]
    ds_read_b64_tr_b16 v[36:37], v229 offset:6272
    ds_read_b64_tr_b16 v[38:39], v229 offset:7040
    s_waitcnt lgkmcnt(7)
    v_mfma_f32_32x32x16_bf16 v[52:67], v[16:19], v[184:187], v[52:67]
    ds_read_b128 v[192:195], v7 offset:0
    ds_read_b64_tr_b16 v[40:41], v229 offset:9216
    ds_read_b64_tr_b16 v[42:43], v229 offset:9984
    v_mfma_f32_32x32x16_bf16 v[68:83], v[20:23], v[184:187], v[68:83]
    ds_read_b64_tr_b16 v[44:45], v229 offset:9280
    ds_read_b64_tr_b16 v[46:47], v229 offset:10048
    v_mfma_f32_32x32x16_bf16 v[84:99], v[184:187], v[24:27], v[84:99]
    ds_read_b64_tr_b16 v[48:49], v229 offset:9344
    ds_read_b64_tr_b16 v[50:51], v229 offset:10112
    s_waitcnt lgkmcnt(7)
    s_waitcnt lgkmcnt(0)
    s_barrier
    v_mfma_f32_32x32x16_bf16 v[52:67], v[28:31], v[188:191], v[52:67]
    ds_read_b128 v[196:199], v4 offset:28672
    ds_read_b64_tr_b16 v[16:17], v229 offset:28672
    ds_read_b64_tr_b16 v[18:19], v229 offset:29440
    v_mfma_f32_32x32x16_bf16 v[68:83], v[32:35], v[188:191], v[68:83]
    ds_read_b64_tr_b16 v[20:21], v229 offset:28736
    ds_read_b64_tr_b16 v[22:23], v229 offset:29504
    v_mfma_f32_32x32x16_bf16 v[84:99], v[188:191], v[36:39], v[84:99]
    ds_read_b64_tr_b16 v[24:25], v229 offset:28800
    ds_read_b64_tr_b16 v[26:27], v229 offset:29568
    v_mfma_f32_32x32x16_bf16 v[52:67], v[40:43], v[192:195], v[52:67]
    ds_read_b128 v[200:203], v5 offset:28672
    ds_read_b64_tr_b16 v[28:29], v229 offset:31744
    ds_read_b64_tr_b16 v[30:31], v229 offset:32512
    v_mfma_f32_32x32x16_bf16 v[68:83], v[44:47], v[192:195], v[68:83]
    ds_read_b64_tr_b16 v[32:33], v229 offset:31808
    ds_read_b64_tr_b16 v[34:35], v229 offset:32576
    v_mfma_f32_32x32x16_bf16 v[84:99], v[192:195], v[48:51], v[84:99]
    ds_read_b64_tr_b16 v[36:37], v229 offset:31872
    ds_read_b64_tr_b16 v[38:39], v229 offset:32640
    s_waitcnt lgkmcnt(7)
    v_mfma_f32_32x32x16_bf16 v[52:67], v[16:19], v[196:199], v[52:67]
    ds_read_b128 v[204:207], v6 offset:28672
    ds_read_b64_tr_b16 v[40:41], v229 offset:34816
    ds_read_b64_tr_b16 v[42:43], v229 offset:35584
    v_mfma_f32_32x32x16_bf16 v[68:83], v[20:23], v[196:199], v[68:83]
    ds_read_b64_tr_b16 v[44:45], v229 offset:34880
    ds_read_b64_tr_b16 v[46:47], v229 offset:35648
    v_mfma_f32_32x32x16_bf16 v[84:99], v[196:199], v[24:27], v[84:99]
    ds_read_b64_tr_b16 v[48:49], v229 offset:34944
    ds_read_b64_tr_b16 v[50:51], v229 offset:35712
    s_waitcnt lgkmcnt(7)
    v_mfma_f32_32x32x16_bf16 v[52:67], v[28:31], v[200:203], v[52:67]
    ds_read_b128 v[208:211], v7 offset:28672
    ds_read_b64_tr_b16 v[16:17], v229 offset:37888
    ds_read_b64_tr_b16 v[18:19], v229 offset:38656
    v_mfma_f32_32x32x16_bf16 v[68:83], v[32:35], v[200:203], v[68:83]
    ds_read_b64_tr_b16 v[20:21], v229 offset:37952
    ds_read_b64_tr_b16 v[22:23], v229 offset:38720
    v_mfma_f32_32x32x16_bf16 v[84:99], v[200:203], v[36:39], v[84:99]
    ds_read_b64_tr_b16 v[24:25], v229 offset:38016
    ds_read_b64_tr_b16 v[26:27], v229 offset:38784
    s_waitcnt lgkmcnt(7)
    s_waitcnt lgkmcnt(0)
    s_barrier
    v_mfma_f32_32x32x16_bf16 v[52:67], v[40:43], v[204:207], v[52:67]
    ds_read_b128 v[212:215], v8 offset:0
    ds_read_b64_tr_b16 v[28:29], v230 offset:0
    ds_read_b64_tr_b16 v[30:31], v230 offset:768
    v_mfma_f32_32x32x16_bf16 v[68:83], v[44:47], v[204:207], v[68:83]
    ds_read_b64_tr_b16 v[32:33], v230 offset:64
    ds_read_b64_tr_b16 v[34:35], v230 offset:832
    v_mfma_f32_32x32x16_bf16 v[84:99], v[204:207], v[48:51], v[84:99]
    ds_read_b64_tr_b16 v[36:37], v230 offset:128
    ds_read_b64_tr_b16 v[38:39], v230 offset:896
    v_mfma_f32_32x32x16_bf16 v[52:67], v[16:19], v[208:211], v[52:67]
    ds_read_b128 v[216:219], v9 offset:0
    ds_read_b64_tr_b16 v[40:41], v230 offset:3072
    ds_read_b64_tr_b16 v[42:43], v230 offset:3840
    v_mfma_f32_32x32x16_bf16 v[68:83], v[20:23], v[208:211], v[68:83]
    ds_read_b64_tr_b16 v[44:45], v230 offset:3136
    ds_read_b64_tr_b16 v[46:47], v230 offset:3904
    v_mfma_f32_32x32x16_bf16 v[84:99], v[208:211], v[24:27], v[84:99]
    ds_read_b64_tr_b16 v[48:49], v230 offset:3200
    ds_read_b64_tr_b16 v[50:51], v230 offset:3968
    s_waitcnt lgkmcnt(7)
    v_mfma_f32_32x32x16_bf16 v[52:67], v[28:31], v[212:215], v[52:67]
    ds_read_b128 v[220:223], v10 offset:0
    ds_read_b64_tr_b16 v[16:17], v230 offset:6144
    ds_read_b64_tr_b16 v[18:19], v230 offset:6912
    v_mfma_f32_32x32x16_bf16 v[68:83], v[32:35], v[212:215], v[68:83]
    ds_read_b64_tr_b16 v[20:21], v230 offset:6208
    ds_read_b64_tr_b16 v[22:23], v230 offset:6976
    v_mfma_f32_32x32x16_bf16 v[84:99], v[212:215], v[36:39], v[84:99]
    ds_read_b64_tr_b16 v[24:25], v230 offset:6272
    ds_read_b64_tr_b16 v[26:27], v230 offset:7040
    s_waitcnt lgkmcnt(7)
    v_mfma_f32_32x32x16_bf16 v[52:67], v[40:43], v[216:219], v[52:67]
    ds_read_b128 v[224:227], v11 offset:0
    ds_read_b64_tr_b16 v[28:29], v230 offset:9216
    ds_read_b64_tr_b16 v[30:31], v230 offset:9984
    v_mfma_f32_32x32x16_bf16 v[68:83], v[44:47], v[216:219], v[68:83]
    ds_read_b64_tr_b16 v[32:33], v230 offset:9280
    ds_read_b64_tr_b16 v[34:35], v230 offset:10048
    v_mfma_f32_32x32x16_bf16 v[84:99], v[216:219], v[48:51], v[84:99]
    ds_read_b64_tr_b16 v[36:37], v230 offset:9344
    ds_read_b64_tr_b16 v[38:39], v230 offset:10112
    s_waitcnt lgkmcnt(7)
    v_mfma_f32_32x32x16_bf16 v[52:67], v[16:19], v[220:223], v[52:67]
    v_mfma_f32_32x32x16_bf16 v[68:83], v[20:23], v[220:223], v[68:83]
    v_mfma_f32_32x32x16_bf16 v[84:99], v[220:223], v[24:27], v[84:99]
    s_waitcnt lgkmcnt(0)
    v_mfma_f32_32x32x16_bf16 v[52:67], v[28:31], v[224:227], v[52:67]
    v_mfma_f32_32x32x16_bf16 v[68:83], v[32:35], v[224:227], v[68:83]
    v_mfma_f32_32x32x16_bf16 v[84:99], v[224:227], v[36:39], v[84:99]
    s_nop 15
    v_and_b32 v2, 15, v0
    v_lshlrev_b32 v2, 4, v2
    v_lshrrev_b32 v1, 5, v0
    v_lshlrev_b32 v1, 9, v1
    v_add_u32 v2, v2, v1
    v_lshrrev_b32 v1, 4, v0
    v_and_b32 v1, 1, v1
    v_lshlrev_b32 v1, 16, v1
    v_add_u32 v2, v2, v1
    v_pk_mul_f32 v[52:53], v[52:53], s[58:59]
    v_pk_mul_f32 v[54:55], v[54:55], s[58:59]
    v_pk_mul_f32 v[56:57], v[56:57], s[58:59]
    v_pk_mul_f32 v[58:59], v[58:59], s[58:59]
    v_pk_mul_f32 v[60:61], v[60:61], s[58:59]
    v_pk_mul_f32 v[62:63], v[62:63], s[58:59]
    v_pk_mul_f32 v[64:65], v[64:65], s[58:59]
    v_pk_mul_f32 v[66:67], v[66:67], s[58:59]
    v_cvt_pk_bf16_f32 v52, v52, v53
    v_cvt_pk_bf16_f32 v53, v54, v55
    v_cvt_pk_bf16_f32 v54, v56, v57
    v_cvt_pk_bf16_f32 v55, v58, v59
    buffer_store_dwordx4 v[52:55], v228, s[20:23], s54 offen sc1
    v_cvt_pk_bf16_f32 v60, v60, v61
    v_cvt_pk_bf16_f32 v61, v62, v63
    v_cvt_pk_bf16_f32 v62, v64, v65
    v_cvt_pk_bf16_f32 v63, v66, v67
    s_add_u32 s46, s54, 65536
    buffer_store_dwordx4 v[60:63], v228, s[20:23], s46 offen sc1
    v_pk_mul_f32 v[68:69], v[68:69], s[60:61]
    v_pk_mul_f32 v[70:71], v[70:71], s[60:61]
    v_pk_mul_f32 v[72:73], v[72:73], s[60:61]
    v_pk_mul_f32 v[74:75], v[74:75], s[60:61]
    v_pk_mul_f32 v[76:77], v[76:77], s[60:61]
    v_pk_mul_f32 v[78:79], v[78:79], s[60:61]
    v_pk_mul_f32 v[80:81], v[80:81], s[60:61]
    v_pk_mul_f32 v[82:83], v[82:83], s[60:61]
    v_cvt_pk_bf16_f32 v68, v68, v69
    v_cvt_pk_bf16_f32 v69, v70, v71
    v_cvt_pk_bf16_f32 v70, v72, v73
    v_cvt_pk_bf16_f32 v71, v74, v75
    buffer_store_dwordx4 v[68:71], v228, s[20:23], s55 offen sc1
    v_cvt_pk_bf16_f32 v76, v76, v77
    v_cvt_pk_bf16_f32 v77, v78, v79
    v_cvt_pk_bf16_f32 v78, v80, v81
    v_cvt_pk_bf16_f32 v79, v82, v83
    s_add_u32 s46, s55, 65536
    buffer_store_dwordx4 v[76:79], v228, s[20:23], s46 offen sc1
    v_cvt_pk_bf16_f32 v84, v84, v85
    v_cvt_pk_bf16_f32 v85, v86, v87
    v_cvt_pk_bf16_f32 v86, v88, v89
    v_cvt_pk_bf16_f32 v87, v90, v91
    buffer_store_dwordx4 v[84:87], v2, s[20:23], s56 offen sc1
    v_cvt_pk_bf16_f32 v92, v92, v93
    v_cvt_pk_bf16_f32 v93, v94, v95
    v_cvt_pk_bf16_f32 v94, v96, v97
    v_cvt_pk_bf16_f32 v95, v98, v99
    s_add_u32 s46, s56, 256
    buffer_store_dwordx4 v[92:95], v2, s[20:23], s46 offen sc1
    s_branch L_gated_mix__mha_block__dense_activation_squared_relu__prompt_kernel_qdone
L_gated_mix__mha_block__dense_activation_squared_relu__prompt_kernel_qv7:
    s_barrier
    ds_read_b128 v[100:103], v4 offset:0
    ds_read_b64_tr_b16 v[16:17], v229 offset:0
    ds_read_b64_tr_b16 v[18:19], v229 offset:768
    ds_read_b64_tr_b16 v[20:21], v229 offset:64
    ds_read_b64_tr_b16 v[22:23], v229 offset:832
    ds_read_b64_tr_b16 v[24:25], v229 offset:128
    ds_read_b64_tr_b16 v[26:27], v229 offset:896
    ds_read_b128 v[104:107], v5 offset:0
    ds_read_b64_tr_b16 v[28:29], v229 offset:3072
    ds_read_b64_tr_b16 v[30:31], v229 offset:3840
    ds_read_b64_tr_b16 v[32:33], v229 offset:3136
    ds_read_b64_tr_b16 v[34:35], v229 offset:3904
    ds_read_b64_tr_b16 v[36:37], v229 offset:3200
    ds_read_b64_tr_b16 v[38:39], v229 offset:3968
    s_waitcnt lgkmcnt(7)
    v_mfma_f32_32x32x16_bf16 v[52:67], v[100:103], v[16:19], 0
    ds_read_b128 v[108:111], v6 offset:0
    ds_read_b64_tr_b16 v[40:41], v229 offset:6144
    ds_read_b64_tr_b16 v[42:43], v229 offset:6912
    v_mfma_f32_32x32x16_bf16 v[68:83], v[100:103], v[20:23], 0
    ds_read_b64_tr_b16 v[44:45], v229 offset:6208
    ds_read_b64_tr_b16 v[46:47], v229 offset:6976
    v_mfma_f32_32x32x16_bf16 v[84:99], v[100:103], v[24:27], 0
    ds_read_b64_tr_b16 v[48:49], v229 offset:6272
    ds_read_b64_tr_b16 v[50:51], v229 offset:7040
    s_waitcnt lgkmcnt(7)
    v_mfma_f32_32x32x16_bf16 v[52:67], v[104:107], v[28:31], v[52:67]
    ds_read_b128 v[112:115], v7 offset:0
    ds_read_b64_tr_b16 v[16:17], v229 offset:9216
    ds_read_b64_tr_b16 v[18:19], v229 offset:9984
    v_mfma_f32_32x32x16_bf16 v[68:83], v[104:107], v[32:35], v[68:83]
    ds_read_b64_tr_b16 v[20:21], v229 offset:9280
    ds_read_b64_tr_b16 v[22:23], v229 offset:10048
    v_mfma_f32_32x32x16_bf16 v[84:99], v[104:107], v[36:39], v[84:99]
    ds_read_b64_tr_b16 v[24:25], v229 offset:9344
    ds_read_b64_tr_b16 v[26:27], v229 offset:10112
    s_waitcnt lgkmcnt(7)
    s_waitcnt lgkmcnt(0)
    s_barrier
    v_mfma_f32_32x32x16_bf16 v[52:67], v[108:111], v[40:43], v[52:67]
    ds_read_b128 v[116:119], v4 offset:28672
    ds_read_b64_tr_b16 v[28:29], v229 offset:28672
    ds_read_b64_tr_b16 v[30:31], v229 offset:29440
    v_mfma_f32_32x32x16_bf16 v[68:83], v[108:111], v[44:47], v[68:83]
    ds_read_b64_tr_b16 v[32:33], v229 offset:28736
    ds_read_b64_tr_b16 v[34:35], v229 offset:29504
    v_mfma_f32_32x32x16_bf16 v[84:99], v[108:111], v[48:51], v[84:99]
    ds_read_b64_tr_b16 v[36:37], v229 offset:28800
    ds_read_b64_tr_b16 v[38:39], v229 offset:29568
    v_mfma_f32_32x32x16_bf16 v[52:67], v[112:115], v[16:19], v[52:67]
    ds_read_b128 v[120:123], v5 offset:28672
    ds_read_b64_tr_b16 v[40:41], v229 offset:31744
    ds_read_b64_tr_b16 v[42:43], v229 offset:32512
    v_mfma_f32_32x32x16_bf16 v[68:83], v[112:115], v[20:23], v[68:83]
    ds_read_b64_tr_b16 v[44:45], v229 offset:31808
    ds_read_b64_tr_b16 v[46:47], v229 offset:32576
    v_mfma_f32_32x32x16_bf16 v[84:99], v[112:115], v[24:27], v[84:99]
    ds_read_b64_tr_b16 v[48:49], v229 offset:31872
    ds_read_b64_tr_b16 v[50:51], v229 offset:32640
    s_waitcnt lgkmcnt(7)
    v_mfma_f32_32x32x16_bf16 v[52:67], v[116:119], v[28:31], v[52:67]
    ds_read_b128 v[124:127], v6 offset:28672
    ds_read_b64_tr_b16 v[16:17], v229 offset:34816
    ds_read_b64_tr_b16 v[18:19], v229 offset:35584
    v_mfma_f32_32x32x16_bf16 v[68:83], v[116:119], v[32:35], v[68:83]
    ds_read_b64_tr_b16 v[20:21], v229 offset:34880
    ds_read_b64_tr_b16 v[22:23], v229 offset:35648
    v_mfma_f32_32x32x16_bf16 v[84:99], v[116:119], v[36:39], v[84:99]
    ds_read_b64_tr_b16 v[24:25], v229 offset:34944
    ds_read_b64_tr_b16 v[26:27], v229 offset:35712
    s_waitcnt lgkmcnt(7)
    v_mfma_f32_32x32x16_bf16 v[52:67], v[120:123], v[40:43], v[52:67]
    ds_read_b128 v[128:131], v7 offset:28672
    ds_read_b64_tr_b16 v[28:29], v229 offset:37888
    ds_read_b64_tr_b16 v[30:31], v229 offset:38656
    v_mfma_f32_32x32x16_bf16 v[68:83], v[120:123], v[44:47], v[68:83]
    ds_read_b64_tr_b16 v[32:33], v229 offset:37952
    ds_read_b64_tr_b16 v[34:35], v229 offset:38720
    v_mfma_f32_32x32x16_bf16 v[84:99], v[120:123], v[48:51], v[84:99]
    ds_read_b64_tr_b16 v[36:37], v229 offset:38016
    ds_read_b64_tr_b16 v[38:39], v229 offset:38784
    s_waitcnt lgkmcnt(7)
    s_waitcnt lgkmcnt(0)
    s_barrier
    v_mfma_f32_32x32x16_bf16 v[52:67], v[124:127], v[16:19], v[52:67]
    ds_read_b128 v[132:135], v8 offset:0
    ds_read_b64_tr_b16 v[40:41], v230 offset:0
    ds_read_b64_tr_b16 v[42:43], v230 offset:768
    v_mfma_f32_32x32x16_bf16 v[68:83], v[124:127], v[20:23], v[68:83]
    ds_read_b64_tr_b16 v[44:45], v230 offset:64
    ds_read_b64_tr_b16 v[46:47], v230 offset:832
    v_mfma_f32_32x32x16_bf16 v[84:99], v[124:127], v[24:27], v[84:99]
    ds_read_b64_tr_b16 v[48:49], v230 offset:128
    ds_read_b64_tr_b16 v[50:51], v230 offset:896
    v_mfma_f32_32x32x16_bf16 v[52:67], v[128:131], v[28:31], v[52:67]
    ds_read_b128 v[136:139], v9 offset:0
    ds_read_b64_tr_b16 v[16:17], v230 offset:3072
    ds_read_b64_tr_b16 v[18:19], v230 offset:3840
    v_mfma_f32_32x32x16_bf16 v[68:83], v[128:131], v[32:35], v[68:83]
    ds_read_b64_tr_b16 v[20:21], v230 offset:3136
    ds_read_b64_tr_b16 v[22:23], v230 offset:3904
    v_mfma_f32_32x32x16_bf16 v[84:99], v[128:131], v[36:39], v[84:99]
    ds_read_b64_tr_b16 v[24:25], v230 offset:3200
    ds_read_b64_tr_b16 v[26:27], v230 offset:3968
    s_waitcnt lgkmcnt(7)
    v_mfma_f32_32x32x16_bf16 v[52:67], v[132:135], v[40:43], v[52:67]
    ds_read_b128 v[140:143], v10 offset:0
    ds_read_b64_tr_b16 v[28:29], v230 offset:6144
    ds_read_b64_tr_b16 v[30:31], v230 offset:6912
    v_mfma_f32_32x32x16_bf16 v[68:83], v[132:135], v[44:47], v[68:83]
    ds_read_b64_tr_b16 v[32:33], v230 offset:6208
    ds_read_b64_tr_b16 v[34:35], v230 offset:6976
    v_mfma_f32_32x32x16_bf16 v[84:99], v[132:135], v[48:51], v[84:99]
    ds_read_b64_tr_b16 v[36:37], v230 offset:6272
    ds_read_b64_tr_b16 v[38:39], v230 offset:7040
    s_waitcnt lgkmcnt(7)
    v_mfma_f32_32x32x16_bf16 v[52:67], v[136:139], v[16:19], v[52:67]
    ds_read_b128 v[144:147], v11 offset:0
    ds_read_b64_tr_b16 v[40:41], v230 offset:9216
    ds_read_b64_tr_b16 v[42:43], v230 offset:9984
    v_mfma_f32_32x32x16_bf16 v[68:83], v[136:139], v[20:23], v[68:83]
    ds_read_b64_tr_b16 v[44:45], v230 offset:9280
    ds_read_b64_tr_b16 v[46:47], v230 offset:10048
    v_mfma_f32_32x32x16_bf16 v[84:99], v[136:139], v[24:27], v[84:99]
    ds_read_b64_tr_b16 v[48:49], v230 offset:9344
    ds_read_b64_tr_b16 v[50:51], v230 offset:10112
    s_waitcnt lgkmcnt(7)
    s_waitcnt lgkmcnt(0)
    s_barrier
    v_mfma_f32_32x32x16_bf16 v[52:67], v[140:143], v[28:31], v[52:67]
    ds_read_b128 v[148:151], v8 offset:28672
    ds_read_b64_tr_b16 v[16:17], v230 offset:28672
    ds_read_b64_tr_b16 v[18:19], v230 offset:29440
    v_mfma_f32_32x32x16_bf16 v[68:83], v[140:143], v[32:35], v[68:83]
    ds_read_b64_tr_b16 v[20:21], v230 offset:28736
    ds_read_b64_tr_b16 v[22:23], v230 offset:29504
    v_mfma_f32_32x32x16_bf16 v[84:99], v[140:143], v[36:39], v[84:99]
    ds_read_b64_tr_b16 v[24:25], v230 offset:28800
    ds_read_b64_tr_b16 v[26:27], v230 offset:29568
    v_mfma_f32_32x32x16_bf16 v[52:67], v[144:147], v[40:43], v[52:67]
    ds_read_b128 v[152:155], v9 offset:28672
    ds_read_b64_tr_b16 v[28:29], v230 offset:31744
    ds_read_b64_tr_b16 v[30:31], v230 offset:32512
    v_mfma_f32_32x32x16_bf16 v[68:83], v[144:147], v[44:47], v[68:83]
    ds_read_b64_tr_b16 v[32:33], v230 offset:31808
    ds_read_b64_tr_b16 v[34:35], v230 offset:32576
    v_mfma_f32_32x32x16_bf16 v[84:99], v[144:147], v[48:51], v[84:99]
    ds_read_b64_tr_b16 v[36:37], v230 offset:31872
    ds_read_b64_tr_b16 v[38:39], v230 offset:32640
    s_waitcnt lgkmcnt(7)
    v_mfma_f32_32x32x16_bf16 v[52:67], v[148:151], v[16:19], v[52:67]
    ds_read_b128 v[156:159], v10 offset:28672
    ds_read_b64_tr_b16 v[40:41], v230 offset:34816
    ds_read_b64_tr_b16 v[42:43], v230 offset:35584
    v_mfma_f32_32x32x16_bf16 v[68:83], v[148:151], v[20:23], v[68:83]
    ds_read_b64_tr_b16 v[44:45], v230 offset:34880
    ds_read_b64_tr_b16 v[46:47], v230 offset:35648
    v_mfma_f32_32x32x16_bf16 v[84:99], v[148:151], v[24:27], v[84:99]
    ds_read_b64_tr_b16 v[48:49], v230 offset:34944
    ds_read_b64_tr_b16 v[50:51], v230 offset:35712
    s_waitcnt lgkmcnt(7)
    v_mfma_f32_32x32x16_bf16 v[52:67], v[152:155], v[28:31], v[52:67]
    ds_read_b128 v[160:163], v11 offset:28672
    ds_read_b64_tr_b16 v[16:17], v230 offset:37888
    ds_read_b64_tr_b16 v[18:19], v230 offset:38656
    v_mfma_f32_32x32x16_bf16 v[68:83], v[152:155], v[32:35], v[68:83]
    ds_read_b64_tr_b16 v[20:21], v230 offset:37952
    ds_read_b64_tr_b16 v[22:23], v230 offset:38720
    v_mfma_f32_32x32x16_bf16 v[84:99], v[152:155], v[36:39], v[84:99]
    ds_read_b64_tr_b16 v[24:25], v230 offset:38016
    ds_read_b64_tr_b16 v[26:27], v230 offset:38784
    s_waitcnt lgkmcnt(7)
    s_waitcnt lgkmcnt(0)
    s_barrier
    v_mfma_f32_32x32x16_bf16 v[52:67], v[156:159], v[40:43], v[52:67]
    ds_read_b128 v[164:167], v12 offset:0
    ds_read_b64_tr_b16 v[28:29], v231 offset:0
    ds_read_b64_tr_b16 v[30:31], v231 offset:768
    v_mfma_f32_32x32x16_bf16 v[68:83], v[156:159], v[44:47], v[68:83]
    ds_read_b64_tr_b16 v[32:33], v231 offset:64
    ds_read_b64_tr_b16 v[34:35], v231 offset:832
    v_mfma_f32_32x32x16_bf16 v[84:99], v[156:159], v[48:51], v[84:99]
    ds_read_b64_tr_b16 v[36:37], v231 offset:128
    ds_read_b64_tr_b16 v[38:39], v231 offset:896
    v_mfma_f32_32x32x16_bf16 v[52:67], v[160:163], v[16:19], v[52:67]
    ds_read_b128 v[168:171], v13 offset:0
    ds_read_b64_tr_b16 v[40:41], v231 offset:3072
    ds_read_b64_tr_b16 v[42:43], v231 offset:3840
    v_mfma_f32_32x32x16_bf16 v[68:83], v[160:163], v[20:23], v[68:83]
    ds_read_b64_tr_b16 v[44:45], v231 offset:3136
    ds_read_b64_tr_b16 v[46:47], v231 offset:3904
    v_mfma_f32_32x32x16_bf16 v[84:99], v[160:163], v[24:27], v[84:99]
    ds_read_b64_tr_b16 v[48:49], v231 offset:3200
    ds_read_b64_tr_b16 v[50:51], v231 offset:3968
    s_waitcnt lgkmcnt(7)
    v_mfma_f32_32x32x16_bf16 v[52:67], v[164:167], v[28:31], v[52:67]
    ds_read_b128 v[172:175], v14 offset:0
    ds_read_b64_tr_b16 v[16:17], v231 offset:6144
    ds_read_b64_tr_b16 v[18:19], v231 offset:6912
    v_mfma_f32_32x32x16_bf16 v[68:83], v[164:167], v[32:35], v[68:83]
    ds_read_b64_tr_b16 v[20:21], v231 offset:6208
    ds_read_b64_tr_b16 v[22:23], v231 offset:6976
    v_mfma_f32_32x32x16_bf16 v[84:99], v[164:167], v[36:39], v[84:99]
    ds_read_b64_tr_b16 v[24:25], v231 offset:6272
    ds_read_b64_tr_b16 v[26:27], v231 offset:7040
    s_waitcnt lgkmcnt(7)
    v_mfma_f32_32x32x16_bf16 v[52:67], v[168:171], v[40:43], v[52:67]
    ds_read_b128 v[176:179], v15 offset:0
    ds_read_b64_tr_b16 v[28:29], v231 offset:9216
    ds_read_b64_tr_b16 v[30:31], v231 offset:9984
    v_mfma_f32_32x32x16_bf16 v[68:83], v[168:171], v[44:47], v[68:83]
    ds_read_b64_tr_b16 v[32:33], v231 offset:9280
    ds_read_b64_tr_b16 v[34:35], v231 offset:10048
    v_mfma_f32_32x32x16_bf16 v[84:99], v[168:171], v[48:51], v[84:99]
    ds_read_b64_tr_b16 v[36:37], v231 offset:9344
    ds_read_b64_tr_b16 v[38:39], v231 offset:10112
    s_waitcnt lgkmcnt(7)
    s_waitcnt lgkmcnt(0)
    s_barrier
    v_mfma_f32_32x32x16_bf16 v[52:67], v[172:175], v[16:19], v[52:67]
    ds_read_b128 v[180:183], v4 offset:0
    ds_read_b64_tr_b16 v[40:41], v229 offset:0
    ds_read_b64_tr_b16 v[42:43], v229 offset:768
    v_mfma_f32_32x32x16_bf16 v[68:83], v[172:175], v[20:23], v[68:83]
    ds_read_b64_tr_b16 v[44:45], v229 offset:64
    ds_read_b64_tr_b16 v[46:47], v229 offset:832
    v_mfma_f32_32x32x16_bf16 v[84:99], v[172:175], v[24:27], v[84:99]
    ds_read_b64_tr_b16 v[48:49], v229 offset:128
    ds_read_b64_tr_b16 v[50:51], v229 offset:896
    v_mfma_f32_32x32x16_bf16 v[52:67], v[176:179], v[28:31], v[52:67]
    ds_read_b128 v[184:187], v5 offset:0
    ds_read_b64_tr_b16 v[16:17], v229 offset:3072
    ds_read_b64_tr_b16 v[18:19], v229 offset:3840
    v_mfma_f32_32x32x16_bf16 v[68:83], v[176:179], v[32:35], v[68:83]
    ds_read_b64_tr_b16 v[20:21], v229 offset:3136
    ds_read_b64_tr_b16 v[22:23], v229 offset:3904
    v_mfma_f32_32x32x16_bf16 v[84:99], v[176:179], v[36:39], v[84:99]
    ds_read_b64_tr_b16 v[24:25], v229 offset:3200
    ds_read_b64_tr_b16 v[26:27], v229 offset:3968
    s_waitcnt lgkmcnt(7)
    v_mfma_f32_32x32x16_bf16 v[52:67], v[180:183], v[40:43], v[52:67]
    ds_read_b128 v[188:191], v6 offset:0
    ds_read_b64_tr_b16 v[28:29], v229 offset:6144
    ds_read_b64_tr_b16 v[30:31], v229 offset:6912
    v_mfma_f32_32x32x16_bf16 v[68:83], v[180:183], v[44:47], v[68:83]
    ds_read_b64_tr_b16 v[32:33], v229 offset:6208
    ds_read_b64_tr_b16 v[34:35], v229 offset:6976
    v_mfma_f32_32x32x16_bf16 v[84:99], v[180:183], v[48:51], v[84:99]
    ds_read_b64_tr_b16 v[36:37], v229 offset:6272
    ds_read_b64_tr_b16 v[38:39], v229 offset:7040
    s_waitcnt lgkmcnt(7)
    v_mfma_f32_32x32x16_bf16 v[52:67], v[184:187], v[16:19], v[52:67]
    ds_read_b128 v[192:195], v7 offset:0
    ds_read_b64_tr_b16 v[40:41], v229 offset:9216
    ds_read_b64_tr_b16 v[42:43], v229 offset:9984
    v_mfma_f32_32x32x16_bf16 v[68:83], v[184:187], v[20:23], v[68:83]
    ds_read_b64_tr_b16 v[44:45], v229 offset:9280
    ds_read_b64_tr_b16 v[46:47], v229 offset:10048
    v_mfma_f32_32x32x16_bf16 v[84:99], v[184:187], v[24:27], v[84:99]
    ds_read_b64_tr_b16 v[48:49], v229 offset:9344
    ds_read_b64_tr_b16 v[50:51], v229 offset:10112
    s_waitcnt lgkmcnt(7)
    s_waitcnt lgkmcnt(0)
    s_barrier
    v_mfma_f32_32x32x16_bf16 v[52:67], v[188:191], v[28:31], v[52:67]
    ds_read_b128 v[196:199], v4 offset:28672
    ds_read_b64_tr_b16 v[16:17], v229 offset:28672
    ds_read_b64_tr_b16 v[18:19], v229 offset:29440
    v_mfma_f32_32x32x16_bf16 v[68:83], v[188:191], v[32:35], v[68:83]
    ds_read_b64_tr_b16 v[20:21], v229 offset:28736
    ds_read_b64_tr_b16 v[22:23], v229 offset:29504
    v_mfma_f32_32x32x16_bf16 v[84:99], v[188:191], v[36:39], v[84:99]
    ds_read_b64_tr_b16 v[24:25], v229 offset:28800
    ds_read_b64_tr_b16 v[26:27], v229 offset:29568
    v_mfma_f32_32x32x16_bf16 v[52:67], v[192:195], v[40:43], v[52:67]
    ds_read_b128 v[200:203], v5 offset:28672
    ds_read_b64_tr_b16 v[28:29], v229 offset:31744
    ds_read_b64_tr_b16 v[30:31], v229 offset:32512
    v_mfma_f32_32x32x16_bf16 v[68:83], v[192:195], v[44:47], v[68:83]
    ds_read_b64_tr_b16 v[32:33], v229 offset:31808
    ds_read_b64_tr_b16 v[34:35], v229 offset:32576
    v_mfma_f32_32x32x16_bf16 v[84:99], v[192:195], v[48:51], v[84:99]
    ds_read_b64_tr_b16 v[36:37], v229 offset:31872
    ds_read_b64_tr_b16 v[38:39], v229 offset:32640
    s_waitcnt lgkmcnt(7)
    v_mfma_f32_32x32x16_bf16 v[52:67], v[196:199], v[16:19], v[52:67]
    ds_read_b128 v[204:207], v6 offset:28672
    ds_read_b64_tr_b16 v[40:41], v229 offset:34816
    ds_read_b64_tr_b16 v[42:43], v229 offset:35584
    v_mfma_f32_32x32x16_bf16 v[68:83], v[196:199], v[20:23], v[68:83]
    ds_read_b64_tr_b16 v[44:45], v229 offset:34880
    ds_read_b64_tr_b16 v[46:47], v229 offset:35648
    v_mfma_f32_32x32x16_bf16 v[84:99], v[196:199], v[24:27], v[84:99]
    ds_read_b64_tr_b16 v[48:49], v229 offset:34944
    ds_read_b64_tr_b16 v[50:51], v229 offset:35712
    s_waitcnt lgkmcnt(7)
    v_mfma_f32_32x32x16_bf16 v[52:67], v[200:203], v[28:31], v[52:67]
    ds_read_b128 v[208:211], v7 offset:28672
    ds_read_b64_tr_b16 v[16:17], v229 offset:37888
    ds_read_b64_tr_b16 v[18:19], v229 offset:38656
    v_mfma_f32_32x32x16_bf16 v[68:83], v[200:203], v[32:35], v[68:83]
    ds_read_b64_tr_b16 v[20:21], v229 offset:37952
    ds_read_b64_tr_b16 v[22:23], v229 offset:38720
    v_mfma_f32_32x32x16_bf16 v[84:99], v[200:203], v[36:39], v[84:99]
    ds_read_b64_tr_b16 v[24:25], v229 offset:38016
    ds_read_b64_tr_b16 v[26:27], v229 offset:38784
    s_waitcnt lgkmcnt(7)
    s_waitcnt lgkmcnt(0)
    s_barrier
    v_mfma_f32_32x32x16_bf16 v[52:67], v[204:207], v[40:43], v[52:67]
    ds_read_b128 v[212:215], v8 offset:0
    ds_read_b64_tr_b16 v[28:29], v230 offset:0
    ds_read_b64_tr_b16 v[30:31], v230 offset:768
    v_mfma_f32_32x32x16_bf16 v[68:83], v[204:207], v[44:47], v[68:83]
    ds_read_b64_tr_b16 v[32:33], v230 offset:64
    ds_read_b64_tr_b16 v[34:35], v230 offset:832
    v_mfma_f32_32x32x16_bf16 v[84:99], v[204:207], v[48:51], v[84:99]
    ds_read_b64_tr_b16 v[36:37], v230 offset:128
    ds_read_b64_tr_b16 v[38:39], v230 offset:896
    v_mfma_f32_32x32x16_bf16 v[52:67], v[208:211], v[16:19], v[52:67]
    ds_read_b128 v[216:219], v9 offset:0
    ds_read_b64_tr_b16 v[40:41], v230 offset:3072
    ds_read_b64_tr_b16 v[42:43], v230 offset:3840
    v_mfma_f32_32x32x16_bf16 v[68:83], v[208:211], v[20:23], v[68:83]
    ds_read_b64_tr_b16 v[44:45], v230 offset:3136
    ds_read_b64_tr_b16 v[46:47], v230 offset:3904
    v_mfma_f32_32x32x16_bf16 v[84:99], v[208:211], v[24:27], v[84:99]
    ds_read_b64_tr_b16 v[48:49], v230 offset:3200
    ds_read_b64_tr_b16 v[50:51], v230 offset:3968
    s_waitcnt lgkmcnt(7)
    v_mfma_f32_32x32x16_bf16 v[52:67], v[212:215], v[28:31], v[52:67]
    ds_read_b128 v[220:223], v10 offset:0
    ds_read_b64_tr_b16 v[16:17], v230 offset:6144
    ds_read_b64_tr_b16 v[18:19], v230 offset:6912
    v_mfma_f32_32x32x16_bf16 v[68:83], v[212:215], v[32:35], v[68:83]
    ds_read_b64_tr_b16 v[20:21], v230 offset:6208
    ds_read_b64_tr_b16 v[22:23], v230 offset:6976
    v_mfma_f32_32x32x16_bf16 v[84:99], v[212:215], v[36:39], v[84:99]
    ds_read_b64_tr_b16 v[24:25], v230 offset:6272
    ds_read_b64_tr_b16 v[26:27], v230 offset:7040
    s_waitcnt lgkmcnt(7)
    v_mfma_f32_32x32x16_bf16 v[52:67], v[216:219], v[40:43], v[52:67]
    ds_read_b128 v[224:227], v11 offset:0
    ds_read_b64_tr_b16 v[28:29], v230 offset:9216
    ds_read_b64_tr_b16 v[30:31], v230 offset:9984
    v_mfma_f32_32x32x16_bf16 v[68:83], v[216:219], v[44:47], v[68:83]
    ds_read_b64_tr_b16 v[32:33], v230 offset:9280
    ds_read_b64_tr_b16 v[34:35], v230 offset:10048
    v_mfma_f32_32x32x16_bf16 v[84:99], v[216:219], v[48:51], v[84:99]
    ds_read_b64_tr_b16 v[36:37], v230 offset:9344
    ds_read_b64_tr_b16 v[38:39], v230 offset:10112
    s_waitcnt lgkmcnt(7)
    v_mfma_f32_32x32x16_bf16 v[52:67], v[220:223], v[16:19], v[52:67]
    v_mfma_f32_32x32x16_bf16 v[68:83], v[220:223], v[20:23], v[68:83]
    v_mfma_f32_32x32x16_bf16 v[84:99], v[220:223], v[24:27], v[84:99]
    s_waitcnt lgkmcnt(0)
    v_mfma_f32_32x32x16_bf16 v[52:67], v[224:227], v[28:31], v[52:67]
    v_mfma_f32_32x32x16_bf16 v[68:83], v[224:227], v[32:35], v[68:83]
    v_mfma_f32_32x32x16_bf16 v[84:99], v[224:227], v[36:39], v[84:99]
    s_nop 15
    v_and_b32 v2, 15, v0
    v_lshlrev_b32 v2, 4, v2
    v_lshrrev_b32 v1, 5, v0
    v_lshlrev_b32 v1, 9, v1
    v_add_u32 v2, v2, v1
    v_lshrrev_b32 v1, 4, v0
    v_and_b32 v1, 1, v1
    v_lshlrev_b32 v1, 16, v1
    v_add_u32 v2, v2, v1
    v_cvt_pk_bf16_f32 v52, v52, v53
    v_cvt_pk_bf16_f32 v53, v54, v55
    v_cvt_pk_bf16_f32 v54, v56, v57
    v_cvt_pk_bf16_f32 v55, v58, v59
    buffer_store_dwordx4 v[52:55], v2, s[20:23], s54 offen sc1
    v_cvt_pk_bf16_f32 v60, v60, v61
    v_cvt_pk_bf16_f32 v61, v62, v63
    v_cvt_pk_bf16_f32 v62, v64, v65
    v_cvt_pk_bf16_f32 v63, v66, v67
    s_add_u32 s46, s54, 256
    buffer_store_dwordx4 v[60:63], v2, s[20:23], s46 offen sc1
    v_cvt_pk_bf16_f32 v68, v68, v69
    v_cvt_pk_bf16_f32 v69, v70, v71
    v_cvt_pk_bf16_f32 v70, v72, v73
    v_cvt_pk_bf16_f32 v71, v74, v75
    buffer_store_dwordx4 v[68:71], v2, s[20:23], s55 offen sc1
    v_cvt_pk_bf16_f32 v76, v76, v77
    v_cvt_pk_bf16_f32 v77, v78, v79
    v_cvt_pk_bf16_f32 v78, v80, v81
    v_cvt_pk_bf16_f32 v79, v82, v83
    s_add_u32 s46, s55, 256
    buffer_store_dwordx4 v[76:79], v2, s[20:23], s46 offen sc1
    v_cvt_pk_bf16_f32 v84, v84, v85
    v_cvt_pk_bf16_f32 v85, v86, v87
    v_cvt_pk_bf16_f32 v86, v88, v89
    v_cvt_pk_bf16_f32 v87, v90, v91
    buffer_store_dwordx4 v[84:87], v2, s[20:23], s56 offen sc1
    v_cvt_pk_bf16_f32 v92, v92, v93
    v_cvt_pk_bf16_f32 v93, v94, v95
    v_cvt_pk_bf16_f32 v94, v96, v97
    v_cvt_pk_bf16_f32 v95, v98, v99
    s_add_u32 s46, s56, 256
    buffer_store_dwordx4 v[92:95], v2, s[20:23], s46 offen sc1
L_gated_mix__mha_block__dense_activation_squared_relu__prompt_kernel_qdone:
    s_waitcnt vmcnt(6)
    v_add_u32 v3, 1, v3
    s_nop 0
    v_readfirstlane_b32 s36, v3
    v_lshlrev_b32 v1, 4, v0
    s_cmp_eq_u32 s38, 15
    s_cbranch_scc1 L_gated_mix__mha_block__dense_activation_squared_relu__prompt_kernel_gate
    s_nop 1
    v_lshlrev_b32 v52, 16, v232
    v_and_b32 v53, 0xffff0000, v232
    v_lshlrev_b32 v54, 16, v233
    v_and_b32 v55, 0xffff0000, v233
    v_lshlrev_b32 v56, 16, v234
    v_and_b32 v57, 0xffff0000, v234
    v_lshlrev_b32 v58, 16, v235
    v_and_b32 v59, 0xffff0000, v235
    v_lshlrev_b32 v60, 16, v236
    v_and_b32 v61, 0xffff0000, v236
    v_lshlrev_b32 v62, 16, v237
    v_and_b32 v63, 0xffff0000, v237
    v_lshlrev_b32 v64, 16, v238
    v_and_b32 v65, 0xffff0000, v238
    v_lshlrev_b32 v66, 16, v239
    v_and_b32 v67, 0xffff0000, v239
    v_lshlrev_b32 v68, 16, v240
    v_and_b32 v69, 0xffff0000, v240
    v_lshlrev_b32 v70, 16, v241
    v_and_b32 v71, 0xffff0000, v241
    v_lshlrev_b32 v72, 16, v242
    v_and_b32 v73, 0xffff0000, v242
    v_lshlrev_b32 v74, 16, v243
    v_and_b32 v75, 0xffff0000, v243
    v_lshlrev_b32 v76, 16, v244
    v_and_b32 v77, 0xffff0000, v244
    v_lshlrev_b32 v78, 16, v245
    v_and_b32 v79, 0xffff0000, v245
    v_lshlrev_b32 v80, 16, v246
    v_and_b32 v81, 0xffff0000, v246
    v_lshlrev_b32 v82, 16, v247
    v_and_b32 v83, 0xffff0000, v247
    v_lshlrev_b32 v84, 16, v248
    v_and_b32 v85, 0xffff0000, v248
    v_lshlrev_b32 v86, 16, v249
    v_and_b32 v87, 0xffff0000, v249
    v_lshlrev_b32 v88, 16, v250
    v_and_b32 v89, 0xffff0000, v250
    v_lshlrev_b32 v90, 16, v251
    v_and_b32 v91, 0xffff0000, v251
    v_lshlrev_b32 v92, 16, v252
    v_and_b32 v93, 0xffff0000, v252
    v_lshlrev_b32 v94, 16, v253
    v_and_b32 v95, 0xffff0000, v253
    v_lshlrev_b32 v96, 16, v254
    v_and_b32 v97, 0xffff0000, v254
    v_lshlrev_b32 v98, 16, v255
    v_and_b32 v99, 0xffff0000, v255
    s_barrier
    ds_read_b64_tr_b16 v[40:41], v230 offset:28672
    ds_read_b64_tr_b16 v[42:43], v230 offset:29440
    ds_read_b64_tr_b16 v[44:45], v230 offset:28736
    ds_read_b64_tr_b16 v[46:47], v230 offset:29504
    ds_read_b64_tr_b16 v[48:49], v230 offset:28800
    ds_read_b64_tr_b16 v[50:51], v230 offset:29568
    ds_read_b64_tr_b16 v[16:17], v230 offset:31744
    ds_read_b64_tr_b16 v[18:19], v230 offset:32512
    ds_read_b64_tr_b16 v[20:21], v230 offset:31808
    ds_read_b64_tr_b16 v[22:23], v230 offset:32576
    ds_read_b64_tr_b16 v[24:25], v230 offset:31872
    ds_read_b64_tr_b16 v[26:27], v230 offset:32640
    s_waitcnt lgkmcnt(6)
    v_mfma_f32_32x32x16_bf16 v[52:67], v[40:43], v[100:103], v[52:67]
    ds_read_b64_tr_b16 v[28:29], v230 offset:34816
    ds_read_b64_tr_b16 v[30:31], v230 offset:35584
    ds_read_b64_tr_b16 v[32:33], v230 offset:34880
    v_mfma_f32_32x32x16_bf16 v[68:83], v[44:47], v[100:103], v[68:83]
    ds_read_b64_tr_b16 v[34:35], v230 offset:35648
    ds_read_b64_tr_b16 v[36:37], v230 offset:34944
    v_mfma_f32_32x32x16_bf16 v[84:99], v[48:51], v[100:103], v[84:99]
    ds_read_b64_tr_b16 v[38:39], v230 offset:35712
    s_waitcnt lgkmcnt(6)
    v_mfma_f32_32x32x16_bf16 v[52:67], v[16:19], v[104:107], v[52:67]
    ds_read_b64_tr_b16 v[40:41], v230 offset:37888
    ds_read_b64_tr_b16 v[42:43], v230 offset:38656
    ds_read_b64_tr_b16 v[44:45], v230 offset:37952
    v_mfma_f32_32x32x16_bf16 v[68:83], v[20:23], v[104:107], v[68:83]
    ds_read_b64_tr_b16 v[46:47], v230 offset:38720
    ds_read_b64_tr_b16 v[48:49], v230 offset:38016
    v_mfma_f32_32x32x16_bf16 v[84:99], v[24:27], v[104:107], v[84:99]
    ds_read_b64_tr_b16 v[50:51], v230 offset:38784
    s_waitcnt lgkmcnt(6)
    s_barrier
    v_mfma_f32_32x32x16_bf16 v[52:67], v[28:31], v[108:111], v[52:67]
    ds_read_b64_tr_b16 v[16:17], v231 offset:0
    ds_read_b64_tr_b16 v[18:19], v231 offset:768
    ds_read_b64_tr_b16 v[20:21], v231 offset:64
    v_mfma_f32_32x32x16_bf16 v[68:83], v[32:35], v[108:111], v[68:83]
    ds_read_b64_tr_b16 v[22:23], v231 offset:832
    ds_read_b64_tr_b16 v[24:25], v231 offset:128
    v_mfma_f32_32x32x16_bf16 v[84:99], v[36:39], v[108:111], v[84:99]
    ds_read_b64_tr_b16 v[26:27], v231 offset:896
    s_waitcnt lgkmcnt(6)
    v_mfma_f32_32x32x16_bf16 v[52:67], v[40:43], v[112:115], v[52:67]
    ds_read_b64_tr_b16 v[28:29], v231 offset:3072
    ds_read_b64_tr_b16 v[30:31], v231 offset:3840
    ds_read_b64_tr_b16 v[32:33], v231 offset:3136
    v_mfma_f32_32x32x16_bf16 v[68:83], v[44:47], v[112:115], v[68:83]
    ds_read_b64_tr_b16 v[34:35], v231 offset:3904
    ds_read_b64_tr_b16 v[36:37], v231 offset:3200
    v_mfma_f32_32x32x16_bf16 v[84:99], v[48:51], v[112:115], v[84:99]
    ds_read_b64_tr_b16 v[38:39], v231 offset:3968
    s_waitcnt lgkmcnt(6)
    v_mfma_f32_32x32x16_bf16 v[52:67], v[16:19], v[116:119], v[52:67]
    ds_read_b64_tr_b16 v[40:41], v231 offset:6144
    ds_read_b64_tr_b16 v[42:43], v231 offset:6912
    ds_read_b64_tr_b16 v[44:45], v231 offset:6208
    v_mfma_f32_32x32x16_bf16 v[68:83], v[20:23], v[116:119], v[68:83]
    ds_read_b64_tr_b16 v[46:47], v231 offset:6976
    ds_read_b64_tr_b16 v[48:49], v231 offset:6272
    v_mfma_f32_32x32x16_bf16 v[84:99], v[24:27], v[116:119], v[84:99]
    ds_read_b64_tr_b16 v[50:51], v231 offset:7040
    s_waitcnt lgkmcnt(6)
    v_mfma_f32_32x32x16_bf16 v[52:67], v[28:31], v[120:123], v[52:67]
    ds_read_b64_tr_b16 v[16:17], v231 offset:9216
    ds_read_b64_tr_b16 v[18:19], v231 offset:9984
    ds_read_b64_tr_b16 v[20:21], v231 offset:9280
    v_mfma_f32_32x32x16_bf16 v[68:83], v[32:35], v[120:123], v[68:83]
    ds_read_b64_tr_b16 v[22:23], v231 offset:10048
    ds_read_b64_tr_b16 v[24:25], v231 offset:9344
    v_mfma_f32_32x32x16_bf16 v[84:99], v[36:39], v[120:123], v[84:99]
    ds_read_b64_tr_b16 v[26:27], v231 offset:10112
    s_waitcnt lgkmcnt(6)
    s_barrier
    v_mfma_f32_32x32x16_bf16 v[52:67], v[40:43], v[124:127], v[52:67]
    ds_read_b64_tr_b16 v[28:29], v229 offset:0
    ds_read_b64_tr_b16 v[30:31], v229 offset:768
    ds_read_b64_tr_b16 v[32:33], v229 offset:64
    v_mfma_f32_32x32x16_bf16 v[68:83], v[44:47], v[124:127], v[68:83]
    ds_read_b64_tr_b16 v[34:35], v229 offset:832
    ds_read_b64_tr_b16 v[36:37], v229 offset:128
    v_mfma_f32_32x32x16_bf16 v[84:99], v[48:51], v[124:127], v[84:99]
    ds_read_b64_tr_b16 v[38:39], v229 offset:896
    s_waitcnt lgkmcnt(6)
    v_mfma_f32_32x32x16_bf16 v[52:67], v[16:19], v[128:131], v[52:67]
    ds_read_b64_tr_b16 v[40:41], v229 offset:3072
    ds_read_b64_tr_b16 v[42:43], v229 offset:3840
    ds_read_b64_tr_b16 v[44:45], v229 offset:3136
    v_mfma_f32_32x32x16_bf16 v[68:83], v[20:23], v[128:131], v[68:83]
    ds_read_b64_tr_b16 v[46:47], v229 offset:3904
    ds_read_b64_tr_b16 v[48:49], v229 offset:3200
    v_mfma_f32_32x32x16_bf16 v[84:99], v[24:27], v[128:131], v[84:99]
    ds_read_b64_tr_b16 v[50:51], v229 offset:3968
    s_waitcnt lgkmcnt(6)
    v_mfma_f32_32x32x16_bf16 v[52:67], v[28:31], v[132:135], v[52:67]
    ds_read_b64_tr_b16 v[16:17], v229 offset:6144
    ds_read_b64_tr_b16 v[18:19], v229 offset:6912
    ds_read_b64_tr_b16 v[20:21], v229 offset:6208
    v_mfma_f32_32x32x16_bf16 v[68:83], v[32:35], v[132:135], v[68:83]
    ds_read_b64_tr_b16 v[22:23], v229 offset:6976
    ds_read_b64_tr_b16 v[24:25], v229 offset:6272
    v_mfma_f32_32x32x16_bf16 v[84:99], v[36:39], v[132:135], v[84:99]
    ds_read_b64_tr_b16 v[26:27], v229 offset:7040
    s_waitcnt lgkmcnt(6)
    v_mfma_f32_32x32x16_bf16 v[52:67], v[40:43], v[136:139], v[52:67]
    ds_read_b64_tr_b16 v[28:29], v229 offset:9216
    ds_read_b64_tr_b16 v[30:31], v229 offset:9984
    ds_read_b64_tr_b16 v[32:33], v229 offset:9280
    v_mfma_f32_32x32x16_bf16 v[68:83], v[44:47], v[136:139], v[68:83]
    ds_read_b64_tr_b16 v[34:35], v229 offset:10048
    ds_read_b64_tr_b16 v[36:37], v229 offset:9344
    v_mfma_f32_32x32x16_bf16 v[84:99], v[48:51], v[136:139], v[84:99]
    ds_read_b64_tr_b16 v[38:39], v229 offset:10112
    s_waitcnt lgkmcnt(6)
    s_waitcnt vmcnt(0)
    s_barrier
    v_mfma_f32_32x32x16_bf16 v[52:67], v[16:19], v[140:143], v[52:67]
    ds_read_b64_tr_b16 v[40:41], v229 offset:28672
    ds_read_b64_tr_b16 v[42:43], v229 offset:29440
    ds_read_b64_tr_b16 v[44:45], v229 offset:28736
    v_mfma_f32_32x32x16_bf16 v[68:83], v[20:23], v[140:143], v[68:83]
    ds_read_b64_tr_b16 v[46:47], v229 offset:29504
    ds_read_b64_tr_b16 v[48:49], v229 offset:28800
    v_mfma_f32_32x32x16_bf16 v[84:99], v[24:27], v[140:143], v[84:99]
    ds_read_b64_tr_b16 v[50:51], v229 offset:29568
    s_waitcnt lgkmcnt(6)
    v_mfma_f32_32x32x16_bf16 v[52:67], v[28:31], v[144:147], v[52:67]
    ds_read_b64_tr_b16 v[16:17], v229 offset:31744
    ds_read_b64_tr_b16 v[18:19], v229 offset:32512
    ds_read_b64_tr_b16 v[20:21], v229 offset:31808
    v_mfma_f32_32x32x16_bf16 v[68:83], v[32:35], v[144:147], v[68:83]
    ds_read_b64_tr_b16 v[22:23], v229 offset:32576
    ds_read_b64_tr_b16 v[24:25], v229 offset:31872
    v_mfma_f32_32x32x16_bf16 v[84:99], v[36:39], v[144:147], v[84:99]
    ds_read_b64_tr_b16 v[26:27], v229 offset:32640
    s_waitcnt lgkmcnt(6)
    v_mfma_f32_32x32x16_bf16 v[52:67], v[40:43], v[148:151], v[52:67]
    ds_read_b64_tr_b16 v[28:29], v229 offset:34816
    ds_read_b64_tr_b16 v[30:31], v229 offset:35584
    ds_read_b64_tr_b16 v[32:33], v229 offset:34880
    v_mfma_f32_32x32x16_bf16 v[68:83], v[44:47], v[148:151], v[68:83]
    ds_read_b64_tr_b16 v[34:35], v229 offset:35648
    ds_read_b64_tr_b16 v[36:37], v229 offset:34944
    v_mfma_f32_32x32x16_bf16 v[84:99], v[48:51], v[148:151], v[84:99]
    ds_read_b64_tr_b16 v[38:39], v229 offset:35712
    s_waitcnt lgkmcnt(6)
    v_mfma_f32_32x32x16_bf16 v[52:67], v[16:19], v[152:155], v[52:67]
    ds_read_b64_tr_b16 v[40:41], v229 offset:37888
    ds_read_b64_tr_b16 v[42:43], v229 offset:38656
    ds_read_b64_tr_b16 v[44:45], v229 offset:37952
    v_mfma_f32_32x32x16_bf16 v[68:83], v[20:23], v[152:155], v[68:83]
    ds_read_b64_tr_b16 v[46:47], v229 offset:38720
    ds_read_b64_tr_b16 v[48:49], v229 offset:38016
    v_mfma_f32_32x32x16_bf16 v[84:99], v[24:27], v[152:155], v[84:99]
    ds_read_b64_tr_b16 v[50:51], v229 offset:38784
    s_waitcnt lgkmcnt(6)
    s_barrier
    v_mfma_f32_32x32x16_bf16 v[52:67], v[28:31], v[156:159], v[52:67]
    ds_read_b64_tr_b16 v[16:17], v230 offset:0
    ds_read_b64_tr_b16 v[18:19], v230 offset:768
    ds_read_b64_tr_b16 v[20:21], v230 offset:64
    v_mfma_f32_32x32x16_bf16 v[68:83], v[32:35], v[156:159], v[68:83]
    ds_read_b64_tr_b16 v[22:23], v230 offset:832
    ds_read_b64_tr_b16 v[24:25], v230 offset:128
    v_mfma_f32_32x32x16_bf16 v[84:99], v[36:39], v[156:159], v[84:99]
    ds_read_b64_tr_b16 v[26:27], v230 offset:896
    s_waitcnt lgkmcnt(6)
    v_mfma_f32_32x32x16_bf16 v[52:67], v[40:43], v[160:163], v[52:67]
    ds_read_b64_tr_b16 v[28:29], v230 offset:3072
    ds_read_b64_tr_b16 v[30:31], v230 offset:3840
    ds_read_b64_tr_b16 v[32:33], v230 offset:3136
    v_mfma_f32_32x32x16_bf16 v[68:83], v[44:47], v[160:163], v[68:83]
    ds_read_b64_tr_b16 v[34:35], v230 offset:3904
    ds_read_b64_tr_b16 v[36:37], v230 offset:3200
    v_mfma_f32_32x32x16_bf16 v[84:99], v[48:51], v[160:163], v[84:99]
    ds_read_b64_tr_b16 v[38:39], v230 offset:3968
    s_waitcnt lgkmcnt(6)
    v_mfma_f32_32x32x16_bf16 v[52:67], v[16:19], v[164:167], v[52:67]
    ds_read_b64_tr_b16 v[40:41], v230 offset:6144
    ds_read_b64_tr_b16 v[42:43], v230 offset:6912
    ds_read_b64_tr_b16 v[44:45], v230 offset:6208
    v_mfma_f32_32x32x16_bf16 v[68:83], v[20:23], v[164:167], v[68:83]
    ds_read_b64_tr_b16 v[46:47], v230 offset:6976
    ds_read_b64_tr_b16 v[48:49], v230 offset:6272
    v_mfma_f32_32x32x16_bf16 v[84:99], v[24:27], v[164:167], v[84:99]
    ds_read_b64_tr_b16 v[50:51], v230 offset:7040
    s_waitcnt lgkmcnt(6)
    v_mfma_f32_32x32x16_bf16 v[52:67], v[28:31], v[168:171], v[52:67]
    ds_read_b64_tr_b16 v[16:17], v230 offset:9216
    ds_read_b64_tr_b16 v[18:19], v230 offset:9984
    ds_read_b64_tr_b16 v[20:21], v230 offset:9280
    v_mfma_f32_32x32x16_bf16 v[68:83], v[32:35], v[168:171], v[68:83]
    ds_read_b64_tr_b16 v[22:23], v230 offset:10048
    ds_read_b64_tr_b16 v[24:25], v230 offset:9344
    v_mfma_f32_32x32x16_bf16 v[84:99], v[36:39], v[168:171], v[84:99]
    ds_read_b64_tr_b16 v[26:27], v230 offset:10112
    s_waitcnt lgkmcnt(6)
    s_barrier
    v_mfma_f32_32x32x16_bf16 v[52:67], v[40:43], v[172:175], v[52:67]
    ds_read_b64_tr_b16 v[28:29], v230 offset:28672
    ds_read_b64_tr_b16 v[30:31], v230 offset:29440
    ds_read_b64_tr_b16 v[32:33], v230 offset:28736
    v_mfma_f32_32x32x16_bf16 v[68:83], v[44:47], v[172:175], v[68:83]
    ds_read_b64_tr_b16 v[34:35], v230 offset:29504
    ds_read_b64_tr_b16 v[36:37], v230 offset:28800
    v_mfma_f32_32x32x16_bf16 v[84:99], v[48:51], v[172:175], v[84:99]
    ds_read_b64_tr_b16 v[38:39], v230 offset:29568
    s_waitcnt lgkmcnt(6)
    v_mfma_f32_32x32x16_bf16 v[52:67], v[16:19], v[176:179], v[52:67]
    ds_read_b64_tr_b16 v[40:41], v230 offset:31744
    ds_read_b64_tr_b16 v[42:43], v230 offset:32512
    ds_read_b64_tr_b16 v[44:45], v230 offset:31808
    v_mfma_f32_32x32x16_bf16 v[68:83], v[20:23], v[176:179], v[68:83]
    ds_read_b64_tr_b16 v[46:47], v230 offset:32576
    ds_read_b64_tr_b16 v[48:49], v230 offset:31872
    v_mfma_f32_32x32x16_bf16 v[84:99], v[24:27], v[176:179], v[84:99]
    ds_read_b64_tr_b16 v[50:51], v230 offset:32640
    s_waitcnt lgkmcnt(6)
    v_mfma_f32_32x32x16_bf16 v[52:67], v[28:31], v[180:183], v[52:67]
    ds_read_b64_tr_b16 v[16:17], v230 offset:34816
    ds_read_b64_tr_b16 v[18:19], v230 offset:35584
    ds_read_b64_tr_b16 v[20:21], v230 offset:34880
    v_mfma_f32_32x32x16_bf16 v[68:83], v[32:35], v[180:183], v[68:83]
    ds_read_b64_tr_b16 v[22:23], v230 offset:35648
    ds_read_b64_tr_b16 v[24:25], v230 offset:34944
    v_mfma_f32_32x32x16_bf16 v[84:99], v[36:39], v[180:183], v[84:99]
    ds_read_b64_tr_b16 v[26:27], v230 offset:35712
    s_waitcnt lgkmcnt(6)
    v_mfma_f32_32x32x16_bf16 v[52:67], v[40:43], v[184:187], v[52:67]
    ds_read_b64_tr_b16 v[28:29], v230 offset:37888
    ds_read_b64_tr_b16 v[30:31], v230 offset:38656
    ds_read_b64_tr_b16 v[32:33], v230 offset:37952
    v_mfma_f32_32x32x16_bf16 v[68:83], v[44:47], v[184:187], v[68:83]
    ds_read_b64_tr_b16 v[34:35], v230 offset:38720
    ds_read_b64_tr_b16 v[36:37], v230 offset:38016
    v_mfma_f32_32x32x16_bf16 v[84:99], v[48:51], v[184:187], v[84:99]
    ds_read_b64_tr_b16 v[38:39], v230 offset:38784
    s_waitcnt lgkmcnt(6)
    s_barrier
    v_mfma_f32_32x32x16_bf16 v[52:67], v[16:19], v[188:191], v[52:67]
    ds_read_b64_tr_b16 v[40:41], v231 offset:0
    ds_read_b64_tr_b16 v[42:43], v231 offset:768
    ds_read_b64_tr_b16 v[44:45], v231 offset:64
    v_mfma_f32_32x32x16_bf16 v[68:83], v[20:23], v[188:191], v[68:83]
    ds_read_b64_tr_b16 v[46:47], v231 offset:832
    ds_read_b64_tr_b16 v[48:49], v231 offset:128
    v_mfma_f32_32x32x16_bf16 v[84:99], v[24:27], v[188:191], v[84:99]
    ds_read_b64_tr_b16 v[50:51], v231 offset:896
    s_waitcnt lgkmcnt(6)
    v_mfma_f32_32x32x16_bf16 v[52:67], v[28:31], v[192:195], v[52:67]
    ds_read_b64_tr_b16 v[16:17], v231 offset:3072
    ds_read_b64_tr_b16 v[18:19], v231 offset:3840
    ds_read_b64_tr_b16 v[20:21], v231 offset:3136
    v_mfma_f32_32x32x16_bf16 v[68:83], v[32:35], v[192:195], v[68:83]
    ds_read_b64_tr_b16 v[22:23], v231 offset:3904
    ds_read_b64_tr_b16 v[24:25], v231 offset:3200
    v_mfma_f32_32x32x16_bf16 v[84:99], v[36:39], v[192:195], v[84:99]
    ds_read_b64_tr_b16 v[26:27], v231 offset:3968
    s_waitcnt lgkmcnt(6)
    v_mfma_f32_32x32x16_bf16 v[52:67], v[40:43], v[196:199], v[52:67]
    ds_read_b64_tr_b16 v[28:29], v231 offset:6144
    ds_read_b64_tr_b16 v[30:31], v231 offset:6912
    ds_read_b64_tr_b16 v[32:33], v231 offset:6208
    v_mfma_f32_32x32x16_bf16 v[68:83], v[44:47], v[196:199], v[68:83]
    ds_read_b64_tr_b16 v[34:35], v231 offset:6976
    ds_read_b64_tr_b16 v[36:37], v231 offset:6272
    v_mfma_f32_32x32x16_bf16 v[84:99], v[48:51], v[196:199], v[84:99]
    ds_read_b64_tr_b16 v[38:39], v231 offset:7040
    s_waitcnt lgkmcnt(6)
    v_mfma_f32_32x32x16_bf16 v[52:67], v[16:19], v[200:203], v[52:67]
    ds_read_b64_tr_b16 v[40:41], v231 offset:9216
    ds_read_b64_tr_b16 v[42:43], v231 offset:9984
    ds_read_b64_tr_b16 v[44:45], v231 offset:9280
    v_mfma_f32_32x32x16_bf16 v[68:83], v[20:23], v[200:203], v[68:83]
    ds_read_b64_tr_b16 v[46:47], v231 offset:10048
    ds_read_b64_tr_b16 v[48:49], v231 offset:9344
    v_mfma_f32_32x32x16_bf16 v[84:99], v[24:27], v[200:203], v[84:99]
    ds_read_b64_tr_b16 v[50:51], v231 offset:10112
    s_waitcnt lgkmcnt(6)
    s_barrier
    v_mfma_f32_32x32x16_bf16 v[52:67], v[28:31], v[204:207], v[52:67]
    ds_read_b64_tr_b16 v[16:17], v229 offset:0
    ds_read_b64_tr_b16 v[18:19], v229 offset:768
    ds_read_b64_tr_b16 v[20:21], v229 offset:64
    v_mfma_f32_32x32x16_bf16 v[68:83], v[32:35], v[204:207], v[68:83]
    ds_read_b64_tr_b16 v[22:23], v229 offset:832
    ds_read_b64_tr_b16 v[24:25], v229 offset:128
    v_mfma_f32_32x32x16_bf16 v[84:99], v[36:39], v[204:207], v[84:99]
    ds_read_b64_tr_b16 v[26:27], v229 offset:896
    s_waitcnt lgkmcnt(6)
    v_mfma_f32_32x32x16_bf16 v[52:67], v[40:43], v[208:211], v[52:67]
    ds_read_b64_tr_b16 v[28:29], v229 offset:3072
    ds_read_b64_tr_b16 v[30:31], v229 offset:3840
    ds_read_b64_tr_b16 v[32:33], v229 offset:3136
    v_mfma_f32_32x32x16_bf16 v[68:83], v[44:47], v[208:211], v[68:83]
    ds_read_b64_tr_b16 v[34:35], v229 offset:3904
    ds_read_b64_tr_b16 v[36:37], v229 offset:3200
    v_mfma_f32_32x32x16_bf16 v[84:99], v[48:51], v[208:211], v[84:99]
    ds_read_b64_tr_b16 v[38:39], v229 offset:3968
    s_waitcnt lgkmcnt(6)
    v_mfma_f32_32x32x16_bf16 v[52:67], v[16:19], v[212:215], v[52:67]
    ds_read_b64_tr_b16 v[40:41], v229 offset:6144
    ds_read_b64_tr_b16 v[42:43], v229 offset:6912
    ds_read_b64_tr_b16 v[44:45], v229 offset:6208
    v_mfma_f32_32x32x16_bf16 v[68:83], v[20:23], v[212:215], v[68:83]
    ds_read_b64_tr_b16 v[46:47], v229 offset:6976
    ds_read_b64_tr_b16 v[48:49], v229 offset:6272
    v_mfma_f32_32x32x16_bf16 v[84:99], v[24:27], v[212:215], v[84:99]
    ds_read_b64_tr_b16 v[50:51], v229 offset:7040
    s_waitcnt lgkmcnt(6)
    v_mfma_f32_32x32x16_bf16 v[52:67], v[28:31], v[216:219], v[52:67]
    ds_read_b64_tr_b16 v[16:17], v229 offset:9216
    ds_read_b64_tr_b16 v[18:19], v229 offset:9984
    ds_read_b64_tr_b16 v[20:21], v229 offset:9280
    v_mfma_f32_32x32x16_bf16 v[68:83], v[32:35], v[216:219], v[68:83]
    ds_read_b64_tr_b16 v[22:23], v229 offset:10048
    ds_read_b64_tr_b16 v[24:25], v229 offset:9344
    v_mfma_f32_32x32x16_bf16 v[84:99], v[36:39], v[216:219], v[84:99]
    ds_read_b64_tr_b16 v[26:27], v229 offset:10112
    s_waitcnt lgkmcnt(6)
    v_mfma_f32_32x32x16_bf16 v[52:67], v[40:43], v[220:223], v[52:67]
    v_mfma_f32_32x32x16_bf16 v[68:83], v[44:47], v[220:223], v[68:83]
    v_mfma_f32_32x32x16_bf16 v[84:99], v[48:51], v[220:223], v[84:99]
    s_waitcnt lgkmcnt(0)
    v_mfma_f32_32x32x16_bf16 v[52:67], v[16:19], v[224:227], v[52:67]
    v_mfma_f32_32x32x16_bf16 v[68:83], v[20:23], v[224:227], v[68:83]
    v_mfma_f32_32x32x16_bf16 v[84:99], v[24:27], v[224:227], v[84:99]
    s_nop 15
    s_mul_i32 s54, s53, 88064
    s_mul_i32 s55, s38, 6144
    s_add_u32 s54, s54, s55
    s_mul_i32 s55, s38, 3
    s_add_u32 s56, s55, 0
    s_cmp_ge_u32 s56, 43
    s_cbranch_scc1 L_gated_mix__mha_block__dense_activation_squared_relu__prompt_kernel_hdone
    v_max_f32 v52, 0, v52
    v_max_f32 v53, 0, v53
    v_max_f32 v54, 0, v54
    v_max_f32 v55, 0, v55
    v_max_f32 v56, 0, v56
    v_max_f32 v57, 0, v57
    v_max_f32 v58, 0, v58
    v_max_f32 v59, 0, v59
    v_max_f32 v60, 0, v60
    v_max_f32 v61, 0, v61
    v_max_f32 v62, 0, v62
    v_max_f32 v63, 0, v63
    v_max_f32 v64, 0, v64
    v_max_f32 v65, 0, v65
    v_max_f32 v66, 0, v66
    v_max_f32 v67, 0, v67
    v_pk_mul_f32 v[52:53], v[52:53], v[52:53]
    v_pk_mul_f32 v[54:55], v[54:55], v[54:55]
    v_pk_mul_f32 v[56:57], v[56:57], v[56:57]
    v_pk_mul_f32 v[58:59], v[58:59], v[58:59]
    v_pk_mul_f32 v[60:61], v[60:61], v[60:61]
    v_pk_mul_f32 v[62:63], v[62:63], v[62:63]
    v_pk_mul_f32 v[64:65], v[64:65], v[64:65]
    v_pk_mul_f32 v[66:67], v[66:67], v[66:67]
    v_cvt_pk_bf16_f32 v52, v52, v53
    v_cvt_pk_bf16_f32 v53, v54, v55
    v_cvt_pk_bf16_f32 v54, v56, v57
    v_cvt_pk_bf16_f32 v55, v58, v59
    s_add_u32 s56, s54, 0x800000
    buffer_store_dwordx4 v[52:55], v1, s[20:23], s56 offen sc1
    v_cvt_pk_bf16_f32 v60, v60, v61
    v_cvt_pk_bf16_f32 v61, v62, v63
    v_cvt_pk_bf16_f32 v62, v64, v65
    v_cvt_pk_bf16_f32 v63, v66, v67
    s_add_u32 s56, s54, 0x800400
    buffer_store_dwordx4 v[60:63], v1, s[20:23], s56 offen sc1
    s_add_u32 s56, s55, 1
    s_cmp_ge_u32 s56, 43
    s_cbranch_scc1 L_gated_mix__mha_block__dense_activation_squared_relu__prompt_kernel_hdone
    v_max_f32 v68, 0, v68
    v_max_f32 v69, 0, v69
    v_max_f32 v70, 0, v70
    v_max_f32 v71, 0, v71
    v_max_f32 v72, 0, v72
    v_max_f32 v73, 0, v73
    v_max_f32 v74, 0, v74
    v_max_f32 v75, 0, v75
    v_max_f32 v76, 0, v76
    v_max_f32 v77, 0, v77
    v_max_f32 v78, 0, v78
    v_max_f32 v79, 0, v79
    v_max_f32 v80, 0, v80
    v_max_f32 v81, 0, v81
    v_max_f32 v82, 0, v82
    v_max_f32 v83, 0, v83
    v_pk_mul_f32 v[68:69], v[68:69], v[68:69]
    v_pk_mul_f32 v[70:71], v[70:71], v[70:71]
    v_pk_mul_f32 v[72:73], v[72:73], v[72:73]
    v_pk_mul_f32 v[74:75], v[74:75], v[74:75]
    v_pk_mul_f32 v[76:77], v[76:77], v[76:77]
    v_pk_mul_f32 v[78:79], v[78:79], v[78:79]
    v_pk_mul_f32 v[80:81], v[80:81], v[80:81]
    v_pk_mul_f32 v[82:83], v[82:83], v[82:83]
    v_cvt_pk_bf16_f32 v68, v68, v69
    v_cvt_pk_bf16_f32 v69, v70, v71
    v_cvt_pk_bf16_f32 v70, v72, v73
    v_cvt_pk_bf16_f32 v71, v74, v75
    s_add_u32 s56, s54, 0x800800
    buffer_store_dwordx4 v[68:71], v1, s[20:23], s56 offen sc1
    v_cvt_pk_bf16_f32 v76, v76, v77
    v_cvt_pk_bf16_f32 v77, v78, v79
    v_cvt_pk_bf16_f32 v78, v80, v81
    v_cvt_pk_bf16_f32 v79, v82, v83
    s_add_u32 s56, s54, 0x800c00
    buffer_store_dwordx4 v[76:79], v1, s[20:23], s56 offen sc1
    s_add_u32 s56, s55, 2
    s_cmp_ge_u32 s56, 43
    s_cbranch_scc1 L_gated_mix__mha_block__dense_activation_squared_relu__prompt_kernel_hdone
    v_max_f32 v84, 0, v84
    v_max_f32 v85, 0, v85
    v_max_f32 v86, 0, v86
    v_max_f32 v87, 0, v87
    v_max_f32 v88, 0, v88
    v_max_f32 v89, 0, v89
    v_max_f32 v90, 0, v90
    v_max_f32 v91, 0, v91
    v_max_f32 v92, 0, v92
    v_max_f32 v93, 0, v93
    v_max_f32 v94, 0, v94
    v_max_f32 v95, 0, v95
    v_max_f32 v96, 0, v96
    v_max_f32 v97, 0, v97
    v_max_f32 v98, 0, v98
    v_max_f32 v99, 0, v99
    v_pk_mul_f32 v[84:85], v[84:85], v[84:85]
    v_pk_mul_f32 v[86:87], v[86:87], v[86:87]
    v_pk_mul_f32 v[88:89], v[88:89], v[88:89]
    v_pk_mul_f32 v[90:91], v[90:91], v[90:91]
    v_pk_mul_f32 v[92:93], v[92:93], v[92:93]
    v_pk_mul_f32 v[94:95], v[94:95], v[94:95]
    v_pk_mul_f32 v[96:97], v[96:97], v[96:97]
    v_pk_mul_f32 v[98:99], v[98:99], v[98:99]
    v_cvt_pk_bf16_f32 v84, v84, v85
    v_cvt_pk_bf16_f32 v85, v86, v87
    v_cvt_pk_bf16_f32 v86, v88, v89
    v_cvt_pk_bf16_f32 v87, v90, v91
    s_add_u32 s56, s54, 0x801000
    buffer_store_dwordx4 v[84:87], v1, s[20:23], s56 offen sc1
    v_cvt_pk_bf16_f32 v92, v92, v93
    v_cvt_pk_bf16_f32 v93, v94, v95
    v_cvt_pk_bf16_f32 v94, v96, v97
    v_cvt_pk_bf16_f32 v95, v98, v99
    s_add_u32 s56, s54, 0x801400
    buffer_store_dwordx4 v[92:95], v1, s[20:23], s56 offen sc1
    s_branch L_gated_mix__mha_block__dense_activation_squared_relu__prompt_kernel_hdone
L_gated_mix__mha_block__dense_activation_squared_relu__prompt_kernel_gate:
    v_lshrrev_b32 v3, 5, v0
    v_lshlrev_b32 v3, 4, v3
    s_add_u32 s61, s39, 0
    s_and_b32 s61, s61, 7
    s_lshl_b32 s61, s61, 7
    s_add_u32 s61, s61, 155648
    v_add_u32 v4, s61, v3
    ds_read_b128 v[16:19], v4 offset:0
    ds_read_b128 v[20:23], v4 offset:32
    ds_read_b128 v[24:27], v4 offset:64
    ds_read_b128 v[28:31], v4 offset:96
    s_waitcnt lgkmcnt(0)
    v_mfma_f32_32x32x16_bf16 v[52:67], v[16:19], v[100:103], 0
    v_mfma_f32_32x32x16_bf16 v[52:67], v[20:23], v[104:107], v[52:67]
    v_mfma_f32_32x32x16_bf16 v[52:67], v[24:27], v[108:111], v[52:67]
    v_mfma_f32_32x32x16_bf16 v[52:67], v[28:31], v[112:115], v[52:67]
    s_barrier
    s_add_u32 s61, s39, 1
    s_and_b32 s61, s61, 7
    s_lshl_b32 s61, s61, 7
    s_add_u32 s61, s61, 155648
    v_add_u32 v4, s61, v3
    ds_read_b128 v[16:19], v4 offset:0
    ds_read_b128 v[20:23], v4 offset:32
    ds_read_b128 v[24:27], v4 offset:64
    ds_read_b128 v[28:31], v4 offset:96
    s_waitcnt lgkmcnt(0)
    v_mfma_f32_32x32x16_bf16 v[52:67], v[16:19], v[116:119], v[52:67]
    v_mfma_f32_32x32x16_bf16 v[52:67], v[20:23], v[120:123], v[52:67]
    v_mfma_f32_32x32x16_bf16 v[52:67], v[24:27], v[124:127], v[52:67]
    v_mfma_f32_32x32x16_bf16 v[52:67], v[28:31], v[128:131], v[52:67]
    s_barrier
    s_add_u32 s61, s39, 2
    s_and_b32 s61, s61, 7
    s_lshl_b32 s61, s61, 7
    s_add_u32 s61, s61, 155648
    v_add_u32 v4, s61, v3
    ds_read_b128 v[16:19], v4 offset:0
    ds_read_b128 v[20:23], v4 offset:32
    ds_read_b128 v[24:27], v4 offset:64
    ds_read_b128 v[28:31], v4 offset:96
    s_waitcnt lgkmcnt(0)
    v_mfma_f32_32x32x16_bf16 v[52:67], v[16:19], v[132:135], v[52:67]
    v_mfma_f32_32x32x16_bf16 v[52:67], v[20:23], v[136:139], v[52:67]
    v_mfma_f32_32x32x16_bf16 v[52:67], v[24:27], v[140:143], v[52:67]
    v_mfma_f32_32x32x16_bf16 v[52:67], v[28:31], v[144:147], v[52:67]
    s_barrier
    s_add_u32 s61, s39, 3
    s_and_b32 s61, s61, 7
    s_lshl_b32 s61, s61, 7
    s_add_u32 s61, s61, 155648
    v_add_u32 v4, s61, v3
    ds_read_b128 v[16:19], v4 offset:0
    ds_read_b128 v[20:23], v4 offset:32
    ds_read_b128 v[24:27], v4 offset:64
    ds_read_b128 v[28:31], v4 offset:96
    s_waitcnt lgkmcnt(0)
    v_mfma_f32_32x32x16_bf16 v[52:67], v[16:19], v[148:151], v[52:67]
    v_mfma_f32_32x32x16_bf16 v[52:67], v[20:23], v[152:155], v[52:67]
    v_mfma_f32_32x32x16_bf16 v[52:67], v[24:27], v[156:159], v[52:67]
    v_mfma_f32_32x32x16_bf16 v[52:67], v[28:31], v[160:163], v[52:67]
    s_waitcnt vmcnt(0)
    s_barrier
    s_add_u32 s61, s39, 4
    s_and_b32 s61, s61, 7
    s_lshl_b32 s61, s61, 7
    s_add_u32 s61, s61, 155648
    v_add_u32 v4, s61, v3
    ds_read_b128 v[16:19], v4 offset:0
    ds_read_b128 v[20:23], v4 offset:32
    ds_read_b128 v[24:27], v4 offset:64
    ds_read_b128 v[28:31], v4 offset:96
    s_waitcnt lgkmcnt(0)
    v_mfma_f32_32x32x16_bf16 v[52:67], v[16:19], v[164:167], v[52:67]
    v_mfma_f32_32x32x16_bf16 v[52:67], v[20:23], v[168:171], v[52:67]
    v_mfma_f32_32x32x16_bf16 v[52:67], v[24:27], v[172:175], v[52:67]
    v_mfma_f32_32x32x16_bf16 v[52:67], v[28:31], v[176:179], v[52:67]
    s_barrier
    s_add_u32 s61, s39, 5
    s_and_b32 s61, s61, 7
    s_lshl_b32 s61, s61, 7
    s_add_u32 s61, s61, 155648
    v_add_u32 v4, s61, v3
    ds_read_b128 v[16:19], v4 offset:0
    ds_read_b128 v[20:23], v4 offset:32
    ds_read_b128 v[24:27], v4 offset:64
    ds_read_b128 v[28:31], v4 offset:96
    s_waitcnt lgkmcnt(0)
    v_mfma_f32_32x32x16_bf16 v[52:67], v[16:19], v[180:183], v[52:67]
    v_mfma_f32_32x32x16_bf16 v[52:67], v[20:23], v[184:187], v[52:67]
    v_mfma_f32_32x32x16_bf16 v[52:67], v[24:27], v[188:191], v[52:67]
    v_mfma_f32_32x32x16_bf16 v[52:67], v[28:31], v[192:195], v[52:67]
    s_barrier
    s_add_u32 s61, s39, 6
    s_and_b32 s61, s61, 7
    s_lshl_b32 s61, s61, 7
    s_add_u32 s61, s61, 155648
    v_add_u32 v4, s61, v3
    ds_read_b128 v[16:19], v4 offset:0
    ds_read_b128 v[20:23], v4 offset:32
    ds_read_b128 v[24:27], v4 offset:64
    ds_read_b128 v[28:31], v4 offset:96
    s_waitcnt lgkmcnt(0)
    v_mfma_f32_32x32x16_bf16 v[52:67], v[16:19], v[196:199], v[52:67]
    v_mfma_f32_32x32x16_bf16 v[52:67], v[20:23], v[200:203], v[52:67]
    v_mfma_f32_32x32x16_bf16 v[52:67], v[24:27], v[204:207], v[52:67]
    v_mfma_f32_32x32x16_bf16 v[52:67], v[28:31], v[208:211], v[52:67]
    s_barrier
    s_add_u32 s61, s39, 7
    s_and_b32 s61, s61, 7
    s_lshl_b32 s61, s61, 7
    s_add_u32 s61, s61, 155648
    v_add_u32 v4, s61, v3
    ds_read_b128 v[16:19], v4 offset:0
    ds_read_b128 v[20:23], v4 offset:32
    ds_read_b128 v[24:27], v4 offset:64
    ds_read_b128 v[28:31], v4 offset:96
    s_waitcnt lgkmcnt(0)
    v_mfma_f32_32x32x16_bf16 v[52:67], v[16:19], v[212:215], v[52:67]
    v_mfma_f32_32x32x16_bf16 v[52:67], v[20:23], v[216:219], v[52:67]
    v_mfma_f32_32x32x16_bf16 v[52:67], v[24:27], v[220:223], v[52:67]
    v_mfma_f32_32x32x16_bf16 v[52:67], v[28:31], v[224:227], v[52:67]
    s_barrier
    s_nop 15
    v_mul_f32 v52, 0xbfb8aa3b, v52
    v_exp_f32 v52, v52
    s_nop 0
    v_add_f32 v52, 1.0, v52
    v_rcp_f32 v52, v52
    v_and_b32 v3, 31, v0
    v_lshlrev_b32 v3, 2, v3
    s_lshl_b32 s56, s53, 7
    s_add_u32 s56, s56, 0xe00000
    s_mov_b32 exec_hi, 0
    buffer_store_dword v52, v3, s[20:23], s56 offen sc1
    s_mov_b64 exec, -1
L_gated_mix__mha_block__dense_activation_squared_relu__prompt_kernel_hdone:
    s_lshl_b32 s57, s53, 6
    s_lshl_b32 s58, s38, 2
    s_add_u32 s57, s57, s58
    s_add_u32 s57, s57, 0xe43000
    s_mov_b32 s34, s57
L_gated_mix__mha_block__dense_activation_squared_relu__prompt_kernel_p2:
    s_and_b32 s40, s2, 7
    s_lshl_b32 s41, s40, 2
    s_lshr_b32 s42, s2, 3
    s_and_b32 s43, s42, 3
    s_add_u32 s41, s41, s43
    s_lshr_b32 s44, s2, 5
    s_lshl_b32 s45, s41, 16
    s_mov_b32 s12, s92
    s_mov_b32 s13, s93
    s_mov_b32 s14, 0x158000
    s_mov_b32 s15, 0x20000
    s_mov_b32 s16, s94
    s_mov_b32 s17, s95
    s_mov_b32 s18, 0x400
    s_mov_b32 s19, 0x20000
    s_mov_b32 s24, s96
    s_mov_b32 s25, s97
    s_mov_b32 s26, 0x80000
    s_mov_b32 s27, 0x20000
    s_mov_b32 s28, s98
    s_mov_b32 s29, s99
    s_mov_b32 s30, 0x200000
    s_mov_b32 s31, 0x20000
    v_lshlrev_b32 v6, 4, v0
    s_and_b32 s48, s3, 3
    s_lshr_b32 s49, s3, 2
    s_lshl_b32 s50, s49, 21
    s_add_u32 s50, s50, s45
    s_lshl_b32 s51, s48, 10
    s_add_u32 s50, s50, s51
    s_add_u32 s50, s50, 0x200000
    s_lshl_b32 s51, s48, 11
    s_lshl_b32 s52, s49, 10
    s_add_u32 s51, s51, s52
    s_lshr_b32 s55, s3, 1
    s_and_b32 s55, s55, 1
    s_xor_b32 s56, s44, 0
    s_lshl_b32 s56, s56, 7
    s_lshl_b32 s57, s55, 6
    s_add_u32 s56, s56, s57
    v_lshrrev_b32 v1, 5, v0
    v_lshlrev_b32 v1, 3, v1
    buffer_load_dwordx2 v[200:201], v1, s[16:19], s56 offen offset:0
    buffer_load_dwordx2 v[202:203], v1, s[16:19], s56 offen offset:16
    buffer_load_dwordx2 v[204:205], v1, s[16:19], s56 offen offset:32
    buffer_load_dwordx2 v[206:207], v1, s[16:19], s56 offen offset:48
    v_mov_b32 v88, 0
    v_mov_b32 v89, 0
    v_mov_b32 v90, 0
    v_mov_b32 v91, 0
    v_mov_b32 v92, 0
    v_mov_b32 v93, 0
    v_mov_b32 v94, 0
    v_mov_b32 v95, 0
    v_mov_b32 v96, 0
    v_mov_b32 v97, 0
    v_mov_b32 v98, 0
    v_mov_b32 v99, 0
    v_mov_b32 v100, 0
    v_mov_b32 v101, 0
    v_mov_b32 v102, 0
    v_mov_b32 v103, 0
    v_add_u32 v2, 38912, v6
    v_add_u32 v3, 0x10000, v6
    v_and_b32 v1, 15, v0
    v_lshrrev_b32 v1, 2, v1
    v_lshrrev_b32 v128, 5, v0
    v_lshlrev_b32 v128, 2, v128
    v_add_u32 v1, v1, v128
    v_lshlrev_b32 v1, 6, v1
    v_lshrrev_b32 v128, 4, v0
    v_and_b32 v128, 1, v128
    v_lshlrev_b32 v128, 5, v128
    v_add_u32 v1, v1, v128
    v_and_b32 v128, 3, v0
    v_lshlrev_b32 v128, 3, v128
    v_add_u32 v129, v1, v128
    s_lshl_b32 s58, s3, 12
    s_add_u32 s58, s58, 131072
    v_add_u32 v4, s58, v129
    v_mov_b32 v7, v129
    v_lshrrev_b32 v1, 2, v0
    v_lshlrev_b32 v1, 10, v1
    v_and_b32 v128, 3, v0
    v_lshlrev_b32 v128, 4, v128
    v_add_u32 v5, v1, v128
    s_mul_i32 s59, s49, 43
    s_lshl_b32 s60, s59, 14
    s_add_u32 s60, s60, s56
    s_lshl_b32 s61, s41, 1
    s_and_b32 s62, s3, 1
    s_add_u32 s61, s61, s62
    s_mov_b32 s37, s61
    s_mul_i32 s61, s61, 88064
    s_lshl_b32 s62, s59, 10
    s_add_u32 s61, s61, s62
    s_add_u32 s61, s61, 0x800000
    v_and_b32 v1, 27, v0
    v_cmp_eq_u32 vcc, 16, v1
    v_mov_b32 v128, 0x3f803f80
    v_mov_b32 v1, 0
    v_cndmask_b32 v1, v1, v128, vcc
    v_mov_b32 v16, v1
    v_mov_b32 v17, v1
    v_mov_b32 v18, v1
    v_mov_b32 v19, v1
    v_mov_b32 v20, v1
    v_mov_b32 v21, v1
    v_mov_b32 v22, v1
    v_mov_b32 v23, v1
    s_mov_b32 s32, 0x0000ffff
    s_mov_b32 s33, 0x0000ffff
    s_lshl_b32 s52, s3, 10
    s_add_u32 s52, s52, 143360
    v_add_u32 v1, s52, v6
    s_barrier
    ds_read_b128 v[8:11], v1
    ds_read_b128 v[12:15], v6 offset:0
    s_waitcnt lgkmcnt(0)
    v_mfma_f32_32x32x16_bf16 v[40:55], v[12:15], v[8:11], 0
    s_nop 7
    s_setprio 0
    ds_read_b128 v[12:15], v6 offset:2048
    s_mov_b64 exec, s[32:33]
    ds_read_b128 v[16:19], v6 offset:1024
    s_mov_b64 exec, -1
    s_add_u32 m0, s51, 16384
    s_add_u32 s52, s50, 8192
    buffer_load_dwordx4 v6, s[20:23], s52 offen sc1 lds
    s_add_u32 m0, s51, 24576
    s_add_u32 s52, s50, 12288
    buffer_load_dwordx4 v6, s[20:23], s52 offen sc1 lds
    s_waitcnt lgkmcnt(0)
    v_exp_f32 v40, v40
    s_setprio 2
    v_exp_f32 v41, v41
    v_exp_f32 v42, v42
    v_exp_f32 v43, v43
    v_exp_f32 v44, v44
    v_exp_f32 v45, v45
    v_mfma_f32_32x32x16_bf16 v[56:71], v[12:15], v[8:11], 0
    v_exp_f32 v46, v46
    v_exp_f32 v47, v47
    v_cvt_pk_bf16_f32 v28, v40, v41
    v_cvt_pk_bf16_f32 v29, v42, v43
    v_cvt_pk_bf16_f32 v30, v44, v45
    v_exp_f32 v48, v48
    v_cvt_pk_bf16_f32 v31, v46, v47
    v_exp_f32 v49, v49
    v_exp_f32 v50, v50
    v_mfma_f32_32x32x16_bf16 v[72:87], v[16:19], v[28:31], 0
    v_exp_f32 v51, v51
    v_exp_f32 v52, v52
    v_exp_f32 v53, v53
    v_exp_f32 v54, v54
    v_exp_f32 v55, v55
    v_cvt_pk_bf16_f32 v32, v48, v49
    v_cvt_pk_bf16_f32 v33, v50, v51
    v_cvt_pk_bf16_f32 v34, v52, v53
    v_cvt_pk_bf16_f32 v35, v54, v55
    s_setprio 0
    ds_read_b128 v[12:15], v6 offset:4096
    s_mov_b64 exec, s[32:33]
    ds_read_b128 v[16:19], v6 offset:3072
    ds_read_b128 v[20:23], v6 offset:1280
    s_mov_b64 exec, -1
    s_add_u32 m0, s51, 32768
    s_add_u32 s52, s50, 16384
    buffer_load_dwordx4 v6, s[20:23], s52 offen sc1 lds
    s_add_u32 m0, s51, 40960
    s_add_u32 s52, s50, 20480
    buffer_load_dwordx4 v6, s[20:23], s52 offen sc1 lds
    s_waitcnt lgkmcnt(0)
    v_exp_f32 v56, v56
    s_setprio 2
    v_exp_f32 v57, v57
    v_mfma_f32_32x32x16_bf16 v[72:87], v[20:23], v[32:35], v[72:87]
    v_exp_f32 v58, v58
    v_exp_f32 v59, v59
    v_exp_f32 v60, v60
    v_exp_f32 v61, v61
    v_mfma_f32_32x32x16_bf16 v[40:55], v[12:15], v[8:11], 0
    v_exp_f32 v62, v62
    v_exp_f32 v63, v63
    v_cvt_pk_bf16_f32 v28, v56, v57
    v_cvt_pk_bf16_f32 v29, v58, v59
    v_cvt_pk_bf16_f32 v30, v60, v61
    v_exp_f32 v64, v64
    v_cvt_pk_bf16_f32 v31, v62, v63
    v_exp_f32 v65, v65
    v_exp_f32 v66, v66
    v_mfma_f32_32x32x16_bf16 v[72:87], v[16:19], v[28:31], v[72:87]
    v_exp_f32 v67, v67
    v_exp_f32 v68, v68
    v_exp_f32 v69, v69
    v_exp_f32 v70, v70
    v_exp_f32 v71, v71
    v_cvt_pk_bf16_f32 v32, v64, v65
    v_cvt_pk_bf16_f32 v33, v66, v67
    v_cvt_pk_bf16_f32 v34, v68, v69
    v_cvt_pk_bf16_f32 v35, v70, v71
    s_setprio 0
    ds_read_b128 v[12:15], v6 offset:6144
    s_mov_b64 exec, s[32:33]
    ds_read_b128 v[16:19], v6 offset:5120
    ds_read_b128 v[20:23], v6 offset:3328
    s_mov_b64 exec, -1
    s_add_u32 m0, s51, 49152
    s_add_u32 s52, s50, 24576
    buffer_load_dwordx4 v6, s[20:23], s52 offen sc1 lds
    s_add_u32 m0, s51, 57344
    s_add_u32 s52, s50, 28672
    buffer_load_dwordx4 v6, s[20:23], s52 offen sc1 lds
    s_waitcnt lgkmcnt(0)
    v_exp_f32 v40, v40
    s_setprio 2
    v_exp_f32 v41, v41
    v_mfma_f32_32x32x16_bf16 v[72:87], v[20:23], v[32:35], v[72:87]
    v_exp_f32 v42, v42
    v_exp_f32 v43, v43
    v_exp_f32 v44, v44
    v_exp_f32 v45, v45
    v_mfma_f32_32x32x16_bf16 v[56:71], v[12:15], v[8:11], 0
    v_exp_f32 v46, v46
    v_exp_f32 v47, v47
    v_cvt_pk_bf16_f32 v28, v40, v41
    v_cvt_pk_bf16_f32 v29, v42, v43
    v_cvt_pk_bf16_f32 v30, v44, v45
    v_exp_f32 v48, v48
    v_cvt_pk_bf16_f32 v31, v46, v47
    v_exp_f32 v49, v49
    v_exp_f32 v50, v50
    v_mfma_f32_32x32x16_bf16 v[72:87], v[16:19], v[28:31], v[72:87]
    v_exp_f32 v51, v51
    v_exp_f32 v52, v52
    v_exp_f32 v53, v53
    v_exp_f32 v54, v54
    v_exp_f32 v55, v55
    v_cvt_pk_bf16_f32 v32, v48, v49
    v_cvt_pk_bf16_f32 v33, v50, v51
    v_cvt_pk_bf16_f32 v34, v52, v53
    v_cvt_pk_bf16_f32 v35, v54, v55
    s_setprio 0
    ds_read_b128 v[12:15], v6 offset:8192
    s_mov_b64 exec, s[32:33]
    ds_read_b128 v[16:19], v6 offset:7168
    ds_read_b128 v[20:23], v6 offset:5376
    s_mov_b64 exec, -1
    s_cmp_eq_u32 s34, 0
    s_cbranch_scc1 L_gated_mix__mha_block__dense_activation_squared_relu__prompt_kernel_nohpub
    s_waitcnt vmcnt(10)
    v_mov_b32 v120, s36
    v_mov_b32 v121, 0
    s_mov_b64 exec, 1
    buffer_store_dword v120, v121, s[20:23], s34 offen sc1
    s_mov_b64 exec, -1
L_gated_mix__mha_block__dense_activation_squared_relu__prompt_kernel_nohpub:
    s_add_u32 m0, s51, 65536
    s_add_u32 s52, s50, 32768
    buffer_load_dwordx4 v6, s[20:23], s52 offen sc1 lds
    s_add_u32 m0, s51, 73728
    s_add_u32 s52, s50, 36864
    buffer_load_dwordx4 v6, s[20:23], s52 offen sc1 lds
    s_waitcnt lgkmcnt(0)
    v_exp_f32 v56, v56
    s_setprio 2
    v_exp_f32 v57, v57
    v_mfma_f32_32x32x16_bf16 v[72:87], v[20:23], v[32:35], v[72:87]
    v_exp_f32 v58, v58
    v_exp_f32 v59, v59
    v_exp_f32 v60, v60
    v_exp_f32 v61, v61
    v_mfma_f32_32x32x16_bf16 v[40:55], v[12:15], v[8:11], 0
    v_exp_f32 v62, v62
    v_exp_f32 v63, v63
    v_cvt_pk_bf16_f32 v28, v56, v57
    v_cvt_pk_bf16_f32 v29, v58, v59
    v_cvt_pk_bf16_f32 v30, v60, v61
    v_exp_f32 v64, v64
    v_cvt_pk_bf16_f32 v31, v62, v63
    v_exp_f32 v65, v65
    v_exp_f32 v66, v66
    v_mfma_f32_32x32x16_bf16 v[72:87], v[16:19], v[28:31], v[72:87]
    v_exp_f32 v67, v67
    v_exp_f32 v68, v68
    v_exp_f32 v69, v69
    v_exp_f32 v70, v70
    v_exp_f32 v71, v71
    v_cvt_pk_bf16_f32 v32, v64, v65
    v_cvt_pk_bf16_f32 v33, v66, v67
    v_cvt_pk_bf16_f32 v34, v68, v69
    v_cvt_pk_bf16_f32 v35, v70, v71
    s_setprio 0
    ds_read_b128 v[12:15], v6 offset:10240
    s_mov_b64 exec, s[32:33]
    ds_read_b128 v[16:19], v6 offset:9216
    ds_read_b128 v[20:23], v6 offset:7424
    s_mov_b64 exec, -1
    s_add_u32 m0, s51, 81920
    s_add_u32 s52, s50, 40960
    buffer_load_dwordx4 v6, s[20:23], s52 offen sc1 lds
    s_add_u32 m0, s51, 90112
    s_add_u32 s52, s50, 45056
    buffer_load_dwordx4 v6, s[20:23], s52 offen sc1 lds
    s_waitcnt lgkmcnt(0)
    v_exp_f32 v40, v40
    s_setprio 2
    v_exp_f32 v41, v41
    v_mfma_f32_32x32x16_bf16 v[72:87], v[20:23], v[32:35], v[72:87]
    v_exp_f32 v42, v42
    v_exp_f32 v43, v43
    v_exp_f32 v44, v44
    v_exp_f32 v45, v45
    v_mfma_f32_32x32x16_bf16 v[56:71], v[12:15], v[8:11], 0
    v_exp_f32 v46, v46
    v_exp_f32 v47, v47
    v_cvt_pk_bf16_f32 v28, v40, v41
    v_cvt_pk_bf16_f32 v29, v42, v43
    v_cvt_pk_bf16_f32 v30, v44, v45
    v_exp_f32 v48, v48
    v_cvt_pk_bf16_f32 v31, v46, v47
    v_exp_f32 v49, v49
    v_exp_f32 v50, v50
    v_mfma_f32_32x32x16_bf16 v[72:87], v[16:19], v[28:31], v[72:87]
    v_exp_f32 v51, v51
    v_exp_f32 v52, v52
    v_exp_f32 v53, v53
    v_exp_f32 v54, v54
    v_exp_f32 v55, v55
    v_cvt_pk_bf16_f32 v32, v48, v49
    v_cvt_pk_bf16_f32 v33, v50, v51
    v_cvt_pk_bf16_f32 v34, v52, v53
    v_cvt_pk_bf16_f32 v35, v54, v55
    s_setprio 0
    ds_read_b128 v[12:15], v6 offset:12288
    s_mov_b64 exec, s[32:33]
    ds_read_b128 v[16:19], v6 offset:11264
    ds_read_b128 v[20:23], v6 offset:9472
    s_mov_b64 exec, -1
    s_add_u32 m0, s51, 98304
    s_add_u32 s52, s50, 49152
    buffer_load_dwordx4 v6, s[20:23], s52 offen sc1 lds
    s_add_u32 m0, s51, 106496
    s_add_u32 s52, s50, 53248
    buffer_load_dwordx4 v6, s[20:23], s52 offen sc1 lds
    s_waitcnt lgkmcnt(0)
    v_exp_f32 v56, v56
    s_setprio 2
    v_exp_f32 v57, v57
    v_mfma_f32_32x32x16_bf16 v[72:87], v[20:23], v[32:35], v[72:87]
    v_exp_f32 v58, v58
    v_exp_f32 v59, v59
    v_exp_f32 v60, v60
    v_exp_f32 v61, v61
    v_mfma_f32_32x32x16_bf16 v[40:55], v[12:15], v[8:11], 0
    v_exp_f32 v62, v62
    v_exp_f32 v63, v63
    v_cvt_pk_bf16_f32 v28, v56, v57
    v_cvt_pk_bf16_f32 v29, v58, v59
    v_cvt_pk_bf16_f32 v30, v60, v61
    v_exp_f32 v64, v64
    v_cvt_pk_bf16_f32 v31, v62, v63
    v_exp_f32 v65, v65
    v_exp_f32 v66, v66
    v_mfma_f32_32x32x16_bf16 v[72:87], v[16:19], v[28:31], v[72:87]
    v_exp_f32 v67, v67
    v_exp_f32 v68, v68
    v_exp_f32 v69, v69
    v_exp_f32 v70, v70
    v_exp_f32 v71, v71
    v_cvt_pk_bf16_f32 v32, v64, v65
    v_cvt_pk_bf16_f32 v33, v66, v67
    v_cvt_pk_bf16_f32 v34, v68, v69
    v_cvt_pk_bf16_f32 v35, v70, v71
    s_setprio 0
    ds_read_b128 v[12:15], v6 offset:14336
    s_mov_b64 exec, s[32:33]
    ds_read_b128 v[16:19], v6 offset:13312
    ds_read_b128 v[20:23], v6 offset:11520
    s_mov_b64 exec, -1
    s_add_u32 m0, s51, 114688
    s_add_u32 s52, s50, 57344
    buffer_load_dwordx4 v6, s[20:23], s52 offen sc1 lds
    s_add_u32 m0, s51, 122880
    s_add_u32 s52, s50, 61440
    buffer_load_dwordx4 v6, s[20:23], s52 offen sc1 lds
    s_waitcnt lgkmcnt(0)
    s_cmp_eq_u32 s49, 1
    s_cbranch_scc0 L_gated_mix__mha_block__dense_activation_squared_relu__prompt_kernel_gb1
    s_waitcnt vmcnt(7)
    s_barrier
L_gated_mix__mha_block__dense_activation_squared_relu__prompt_kernel_gb1:
    v_exp_f32 v40, v40
    s_setprio 2
    v_exp_f32 v41, v41
    v_mfma_f32_32x32x16_bf16 v[72:87], v[20:23], v[32:35], v[72:87]
    v_exp_f32 v42, v42
    v_exp_f32 v43, v43
    v_exp_f32 v44, v44
    v_exp_f32 v45, v45
    v_mfma_f32_32x32x16_bf16 v[56:71], v[12:15], v[8:11], 0
    v_exp_f32 v46, v46
    v_exp_f32 v47, v47
    v_cvt_pk_bf16_f32 v28, v40, v41
    v_cvt_pk_bf16_f32 v29, v42, v43
    v_cvt_pk_bf16_f32 v30, v44, v45
    v_exp_f32 v48, v48
    v_cvt_pk_bf16_f32 v31, v46, v47
    v_exp_f32 v49, v49
    v_exp_f32 v50, v50
    v_mfma_f32_32x32x16_bf16 v[72:87], v[16:19], v[28:31], v[72:87]
    v_exp_f32 v51, v51
    v_exp_f32 v52, v52
    v_exp_f32 v53, v53
    v_exp_f32 v54, v54
    v_exp_f32 v55, v55
    v_cvt_pk_bf16_f32 v32, v48, v49
    v_cvt_pk_bf16_f32 v33, v50, v51
    v_cvt_pk_bf16_f32 v34, v52, v53
    v_cvt_pk_bf16_f32 v35, v54, v55
    s_setprio 0
    s_cmp_eq_u32 s49, 0
    s_cbranch_scc0 L_gated_mix__mha_block__dense_activation_squared_relu__prompt_kernel_gb2
    s_waitcnt vmcnt(7)
    s_barrier
L_gated_mix__mha_block__dense_activation_squared_relu__prompt_kernel_gb2:
    ds_read_b128 v[12:15], v6 offset:16384
    s_mov_b64 exec, s[32:33]
    ds_read_b128 v[16:19], v6 offset:15360
    ds_read_b128 v[20:23], v6 offset:13568
    s_mov_b64 exec, -1
    s_lshr_b32 s38, s2, 3
    s_lshl_b32 s38, s38, 3
    s_add_u32 s38, s38, s3
    s_lshl_b32 s39, s38, 11
    s_mul_i32 s38, s38, 5504
    s_add_u32 s52, s38, 0
    buffer_load_dwordx4 v[132:135], v6, s[12:15], s52 offen
    s_waitcnt lgkmcnt(0)
    v_exp_f32 v56, v56
    s_setprio 2
    v_exp_f32 v57, v57
    v_mfma_f32_32x32x16_bf16 v[72:87], v[20:23], v[32:35], v[72:87]
    v_exp_f32 v58, v58
    v_exp_f32 v59, v59
    v_exp_f32 v60, v60
    v_exp_f32 v61, v61
    v_mfma_f32_32x32x16_bf16 v[40:55], v[12:15], v[8:11], 0
    v_exp_f32 v62, v62
    v_exp_f32 v63, v63
    v_cvt_pk_bf16_f32 v28, v56, v57
    v_cvt_pk_bf16_f32 v29, v58, v59
    v_cvt_pk_bf16_f32 v30, v60, v61
    v_exp_f32 v64, v64
    v_cvt_pk_bf16_f32 v31, v62, v63
    v_exp_f32 v65, v65
    v_exp_f32 v66, v66
    v_mfma_f32_32x32x16_bf16 v[72:87], v[16:19], v[28:31], v[72:87]
    v_exp_f32 v67, v67
    v_exp_f32 v68, v68
    v_exp_f32 v69, v69
    v_exp_f32 v70, v70
    v_exp_f32 v71, v71
    v_cvt_pk_bf16_f32 v32, v64, v65
    v_cvt_pk_bf16_f32 v33, v66, v67
    v_cvt_pk_bf16_f32 v34, v68, v69
    v_cvt_pk_bf16_f32 v35, v70, v71
    s_setprio 0
    ds_read_b128 v[12:15], v6 offset:18432
    s_mov_b64 exec, s[32:33]
    ds_read_b128 v[16:19], v6 offset:17408
    ds_read_b128 v[20:23], v6 offset:15616
    s_mov_b64 exec, -1
    s_add_u32 s52, s38, 1024
    buffer_load_dwordx4 v[132:135], v6, s[12:15], s52 offen
    s_waitcnt lgkmcnt(0)
    v_exp_f32 v40, v40
    s_setprio 2
    v_exp_f32 v41, v41
    v_mfma_f32_32x32x16_bf16 v[72:87], v[20:23], v[32:35], v[72:87]
    v_exp_f32 v42, v42
    v_exp_f32 v43, v43
    v_exp_f32 v44, v44
    v_exp_f32 v45, v45
    v_mfma_f32_32x32x16_bf16 v[56:71], v[12:15], v[8:11], 0
    v_exp_f32 v46, v46
    v_exp_f32 v47, v47
    v_cvt_pk_bf16_f32 v28, v40, v41
    v_cvt_pk_bf16_f32 v29, v42, v43
    v_cvt_pk_bf16_f32 v30, v44, v45
    v_exp_f32 v48, v48
    v_cvt_pk_bf16_f32 v31, v46, v47
    v_exp_f32 v49, v49
    v_exp_f32 v50, v50
    v_mfma_f32_32x32x16_bf16 v[72:87], v[16:19], v[28:31], v[72:87]
    v_exp_f32 v51, v51
    v_exp_f32 v52, v52
    v_exp_f32 v53, v53
    v_exp_f32 v54, v54
    v_exp_f32 v55, v55
    v_cvt_pk_bf16_f32 v32, v48, v49
    v_cvt_pk_bf16_f32 v33, v50, v51
    v_cvt_pk_bf16_f32 v34, v52, v53
    v_cvt_pk_bf16_f32 v35, v54, v55
    s_setprio 0
    ds_read_b128 v[12:15], v6 offset:20480
    s_mov_b64 exec, s[32:33]
    ds_read_b128 v[16:19], v6 offset:19456
    ds_read_b128 v[20:23], v6 offset:17664
    s_mov_b64 exec, -1
    s_add_u32 s52, s38, 2048
    buffer_load_dwordx4 v[132:135], v6, s[12:15], s52 offen
    s_waitcnt lgkmcnt(0)
    v_exp_f32 v56, v56
    s_setprio 2
    v_exp_f32 v57, v57
    v_mfma_f32_32x32x16_bf16 v[72:87], v[20:23], v[32:35], v[72:87]
    v_exp_f32 v58, v58
    v_exp_f32 v59, v59
    v_exp_f32 v60, v60
    v_exp_f32 v61, v61
    v_mfma_f32_32x32x16_bf16 v[40:55], v[12:15], v[8:11], 0
    v_exp_f32 v62, v62
    v_exp_f32 v63, v63
    v_cvt_pk_bf16_f32 v28, v56, v57
    v_cvt_pk_bf16_f32 v29, v58, v59
    v_cvt_pk_bf16_f32 v30, v60, v61
    v_exp_f32 v64, v64
    v_cvt_pk_bf16_f32 v31, v62, v63
    v_exp_f32 v65, v65
    v_exp_f32 v66, v66
    v_mfma_f32_32x32x16_bf16 v[72:87], v[16:19], v[28:31], v[72:87]
    v_exp_f32 v67, v67
    v_exp_f32 v68, v68
    v_exp_f32 v69, v69
    v_exp_f32 v70, v70
    v_exp_f32 v71, v71
    v_cvt_pk_bf16_f32 v32, v64, v65
    v_cvt_pk_bf16_f32 v33, v66, v67
    v_cvt_pk_bf16_f32 v34, v68, v69
    v_cvt_pk_bf16_f32 v35, v70, v71
    s_setprio 0
    ds_read_b128 v[12:15], v6 offset:22528
    s_mov_b64 exec, s[32:33]
    ds_read_b128 v[16:19], v6 offset:21504
    ds_read_b128 v[20:23], v6 offset:19712
    s_mov_b64 exec, -1
    s_add_u32 s52, s38, 3072
    buffer_load_dwordx4 v[132:135], v6, s[12:15], s52 offen
    s_waitcnt lgkmcnt(0)
    v_exp_f32 v40, v40
    s_setprio 2
    v_exp_f32 v41, v41
    v_mfma_f32_32x32x16_bf16 v[72:87], v[20:23], v[32:35], v[72:87]
    v_exp_f32 v42, v42
    v_exp_f32 v43, v43
    v_exp_f32 v44, v44
    v_exp_f32 v45, v45
    v_mfma_f32_32x32x16_bf16 v[56:71], v[12:15], v[8:11], 0
    v_exp_f32 v46, v46
    v_exp_f32 v47, v47
    v_cvt_pk_bf16_f32 v28, v40, v41
    v_cvt_pk_bf16_f32 v29, v42, v43
    v_cvt_pk_bf16_f32 v30, v44, v45
    v_exp_f32 v48, v48
    v_cvt_pk_bf16_f32 v31, v46, v47
    v_exp_f32 v49, v49
    v_exp_f32 v50, v50
    v_mfma_f32_32x32x16_bf16 v[72:87], v[16:19], v[28:31], v[72:87]
    v_exp_f32 v51, v51
    v_exp_f32 v52, v52
    v_exp_f32 v53, v53
    v_exp_f32 v54, v54
    v_exp_f32 v55, v55
    v_cvt_pk_bf16_f32 v32, v48, v49
    v_cvt_pk_bf16_f32 v33, v50, v51
    v_cvt_pk_bf16_f32 v34, v52, v53
    v_cvt_pk_bf16_f32 v35, v54, v55
    s_setprio 0
    ds_read_b128 v[12:15], v6 offset:24576
    s_mov_b64 exec, s[32:33]
    ds_read_b128 v[16:19], v6 offset:23552
    ds_read_b128 v[20:23], v6 offset:21760
    s_mov_b64 exec, -1
    s_add_u32 s52, s38, 4096
    buffer_load_dwordx4 v[132:135], v6, s[12:15], s52 offen
    s_waitcnt lgkmcnt(0)
    s_cmp_eq_u32 s49, 1
    s_cbranch_scc0 L_gated_mix__mha_block__dense_activation_squared_relu__prompt_kernel_gb3
    s_waitcnt vmcnt(5)
    s_barrier
L_gated_mix__mha_block__dense_activation_squared_relu__prompt_kernel_gb3:
    v_exp_f32 v56, v56
    s_setprio 2
    v_exp_f32 v57, v57
    v_mfma_f32_32x32x16_bf16 v[72:87], v[20:23], v[32:35], v[72:87]
    v_exp_f32 v58, v58
    v_exp_f32 v59, v59
    v_exp_f32 v60, v60
    v_exp_f32 v61, v61
    v_mfma_f32_32x32x16_bf16 v[40:55], v[12:15], v[8:11], 0
    v_exp_f32 v62, v62
    v_exp_f32 v63, v63
    v_cvt_pk_bf16_f32 v28, v56, v57
    v_cvt_pk_bf16_f32 v29, v58, v59
    v_cvt_pk_bf16_f32 v30, v60, v61
    v_exp_f32 v64, v64
    v_cvt_pk_bf16_f32 v31, v62, v63
    v_exp_f32 v65, v65
    v_exp_f32 v66, v66
    v_mfma_f32_32x32x16_bf16 v[72:87], v[16:19], v[28:31], v[72:87]
    v_exp_f32 v67, v67
    v_exp_f32 v68, v68
    v_exp_f32 v69, v69
    v_exp_f32 v70, v70
    v_exp_f32 v71, v71
    v_cvt_pk_bf16_f32 v32, v64, v65
    v_cvt_pk_bf16_f32 v33, v66, v67
    v_cvt_pk_bf16_f32 v34, v68, v69
    v_cvt_pk_bf16_f32 v35, v70, v71
    s_setprio 0
    s_cmp_eq_u32 s49, 0
    s_cbranch_scc0 L_gated_mix__mha_block__dense_activation_squared_relu__prompt_kernel_gb4
    s_waitcnt vmcnt(5)
    s_barrier
L_gated_mix__mha_block__dense_activation_squared_relu__prompt_kernel_gb4:
    ds_read_b128 v[12:15], v6 offset:26624
    s_mov_b64 exec, s[32:33]
    ds_read_b128 v[16:19], v6 offset:25600
    ds_read_b128 v[20:23], v6 offset:23808
    s_mov_b64 exec, -1
    s_lshl_b32 s46, s37, 6
    s_add_u32 s46, s46, 0xe43000
    v_and_b32 v1, 15, v0
    v_lshlrev_b32 v1, 2, v1
    buffer_load_dword v128, v1, s[20:23], s46 offen sc1
    s_add_u32 s52, s38, 5120
    buffer_load_dwordx4 v[132:135], v6, s[12:15], s52 offen
    s_waitcnt lgkmcnt(0)
    v_exp_f32 v40, v40
    s_setprio 2
    v_exp_f32 v41, v41
    v_mfma_f32_32x32x16_bf16 v[72:87], v[20:23], v[32:35], v[72:87]
    v_exp_f32 v42, v42
    v_exp_f32 v43, v43
    v_exp_f32 v44, v44
    v_exp_f32 v45, v45
    v_mfma_f32_32x32x16_bf16 v[56:71], v[12:15], v[8:11], 0
    v_exp_f32 v46, v46
    v_exp_f32 v47, v47
    v_cvt_pk_bf16_f32 v28, v40, v41
    v_cvt_pk_bf16_f32 v29, v42, v43
    v_cvt_pk_bf16_f32 v30, v44, v45
    v_exp_f32 v48, v48
    v_cvt_pk_bf16_f32 v31, v46, v47
    v_exp_f32 v49, v49
    v_exp_f32 v50, v50
    v_mfma_f32_32x32x16_bf16 v[72:87], v[16:19], v[28:31], v[72:87]
    v_exp_f32 v51, v51
    v_exp_f32 v52, v52
    v_exp_f32 v53, v53
    v_exp_f32 v54, v54
    v_exp_f32 v55, v55
    v_cvt_pk_bf16_f32 v32, v48, v49
    v_cvt_pk_bf16_f32 v33, v50, v51
    v_cvt_pk_bf16_f32 v34, v52, v53
    v_cvt_pk_bf16_f32 v35, v54, v55
    s_setprio 0
    ds_read_b128 v[12:15], v6 offset:28672
    s_mov_b64 exec, s[32:33]
    ds_read_b128 v[16:19], v6 offset:27648
    ds_read_b128 v[20:23], v6 offset:25856
    s_mov_b64 exec, -1
    s_add_u32 s52, s39, 0
    buffer_load_dwordx4 v[132:135], v6, s[24:27], s52 offen
    s_waitcnt lgkmcnt(0)
    v_exp_f32 v56, v56
    s_setprio 2
    v_exp_f32 v57, v57
    v_mfma_f32_32x32x16_bf16 v[72:87], v[20:23], v[32:35], v[72:87]
    v_exp_f32 v58, v58
    v_exp_f32 v59, v59
    v_exp_f32 v60, v60
    v_exp_f32 v61, v61
    v_mfma_f32_32x32x16_bf16 v[40:55], v[12:15], v[8:11], 0
    v_exp_f32 v62, v62
    v_exp_f32 v63, v63
    v_cvt_pk_bf16_f32 v28, v56, v57
    v_cvt_pk_bf16_f32 v29, v58, v59
    v_cvt_pk_bf16_f32 v30, v60, v61
    v_exp_f32 v64, v64
    v_cvt_pk_bf16_f32 v31, v62, v63
    v_exp_f32 v65, v65
    v_exp_f32 v66, v66
    v_mfma_f32_32x32x16_bf16 v[72:87], v[16:19], v[28:31], v[72:87]
    v_exp_f32 v67, v67
    v_exp_f32 v68, v68
    v_exp_f32 v69, v69
    v_exp_f32 v70, v70
    v_exp_f32 v71, v71
    v_cvt_pk_bf16_f32 v32, v64, v65
    v_cvt_pk_bf16_f32 v33, v66, v67
    v_cvt_pk_bf16_f32 v34, v68, v69
    v_cvt_pk_bf16_f32 v35, v70, v71
    s_setprio 0
    ds_read_b128 v[12:15], v6 offset:30720
    s_mov_b64 exec, s[32:33]
    ds_read_b128 v[16:19], v6 offset:29696
    ds_read_b128 v[20:23], v6 offset:27904
    s_mov_b64 exec, -1
    s_add_u32 s52, s39, 1024
    buffer_load_dwordx4 v[132:135], v6, s[24:27], s52 offen
    s_waitcnt lgkmcnt(0)
    v_exp_f32 v40, v40
    s_setprio 2
    v_exp_f32 v41, v41
    v_mfma_f32_32x32x16_bf16 v[72:87], v[20:23], v[32:35], v[72:87]
    v_exp_f32 v42, v42
    v_exp_f32 v43, v43
    v_exp_f32 v44, v44
    v_exp_f32 v45, v45
    v_mfma_f32_32x32x16_bf16 v[56:71], v[12:15], v[8:11], 0
    v_exp_f32 v46, v46
    v_exp_f32 v47, v47
    v_cvt_pk_bf16_f32 v28, v40, v41
    v_cvt_pk_bf16_f32 v29, v42, v43
    v_cvt_pk_bf16_f32 v30, v44, v45
    v_exp_f32 v48, v48
    v_cvt_pk_bf16_f32 v31, v46, v47
    v_exp_f32 v49, v49
    v_exp_f32 v50, v50
    v_mfma_f32_32x32x16_bf16 v[72:87], v[16:19], v[28:31], v[72:87]
    v_exp_f32 v51, v51
    v_exp_f32 v52, v52
    v_exp_f32 v53, v53
    v_exp_f32 v54, v54
    v_exp_f32 v55, v55
    v_cvt_pk_bf16_f32 v32, v48, v49
    v_cvt_pk_bf16_f32 v33, v50, v51
    v_cvt_pk_bf16_f32 v34, v52, v53
    v_cvt_pk_bf16_f32 v35, v54, v55
    s_setprio 0
    ds_read_b128 v[12:15], v6 offset:32768
    s_mov_b64 exec, s[32:33]
    ds_read_b128 v[16:19], v6 offset:31744
    ds_read_b128 v[20:23], v6 offset:29952
    s_mov_b64 exec, -1
    s_waitcnt lgkmcnt(0)
    v_exp_f32 v56, v56
    s_setprio 2
    v_exp_f32 v57, v57
    v_mfma_f32_32x32x16_bf16 v[72:87], v[20:23], v[32:35], v[72:87]
    v_exp_f32 v58, v58
    v_exp_f32 v59, v59
    v_exp_f32 v60, v60
    v_exp_f32 v61, v61
    v_mfma_f32_32x32x16_bf16 v[40:55], v[12:15], v[8:11], 0
    v_exp_f32 v62, v62
    v_exp_f32 v63, v63
    v_cvt_pk_bf16_f32 v28, v56, v57
    v_cvt_pk_bf16_f32 v29, v58, v59
    v_cvt_pk_bf16_f32 v30, v60, v61
    v_exp_f32 v64, v64
    v_cvt_pk_bf16_f32 v31, v62, v63
    v_exp_f32 v65, v65
    v_exp_f32 v66, v66
    v_mfma_f32_32x32x16_bf16 v[72:87], v[16:19], v[28:31], v[72:87]
    v_exp_f32 v67, v67
    v_exp_f32 v68, v68
    v_exp_f32 v69, v69
    v_exp_f32 v70, v70
    v_exp_f32 v71, v71
    v_cvt_pk_bf16_f32 v32, v64, v65
    v_cvt_pk_bf16_f32 v33, v66, v67
    v_cvt_pk_bf16_f32 v34, v68, v69
    v_cvt_pk_bf16_f32 v35, v70, v71
    s_setprio 0
    ds_read_b128 v[12:15], v6 offset:34816
    s_mov_b64 exec, s[32:33]
    ds_read_b128 v[16:19], v6 offset:33792
    ds_read_b128 v[20:23], v6 offset:32000
    s_mov_b64 exec, -1
    s_waitcnt vmcnt(3)
    v_cmp_ne_u32 s[52:53], s36, v128
    s_nop 1
    s_cmp_eq_u64 s[52:53], 0
    s_cbranch_scc1 L_gated_mix__mha_block__dense_activation_squared_relu__prompt_kernel_fhok
    s_mov_b32 s52, 16384
L_gated_mix__mha_block__dense_activation_squared_relu__prompt_kernel_pollh:
    buffer_load_dword v120, v1, s[20:23], s46 offen sc1
    s_waitcnt vmcnt(0)
    v_cmp_ne_u32 s[54:55], s36, v120
    s_nop 1
    s_cmp_eq_u64 s[54:55], 0
    s_cbranch_scc1 L_gated_mix__mha_block__dense_activation_squared_relu__prompt_kernel_pollh_ok
    s_sleep 2
    s_sub_u32 s52, s52, 1
    s_cmp_lg_u32 s52, 0
    s_cbranch_scc1 L_gated_mix__mha_block__dense_activation_squared_relu__prompt_kernel_pollh
L_gated_mix__mha_block__dense_activation_squared_relu__prompt_kernel_pollh_ok:
L_gated_mix__mha_block__dense_activation_squared_relu__prompt_kernel_fhok:
    s_waitcnt lgkmcnt(0)
    v_exp_f32 v40, v40
    s_setprio 2
    v_exp_f32 v41, v41
    v_mfma_f32_32x32x16_bf16 v[72:87], v[20:23], v[32:35], v[72:87]
    v_exp_f32 v42, v42
    v_exp_f32 v43, v43
    v_exp_f32 v44, v44
    v_exp_f32 v45, v45
    v_mfma_f32_32x32x16_bf16 v[56:71], v[12:15], v[8:11], 0
    v_exp_f32 v46, v46
    v_exp_f32 v47, v47
    v_cvt_pk_bf16_f32 v28, v40, v41
    v_cvt_pk_bf16_f32 v29, v42, v43
    v_cvt_pk_bf16_f32 v30, v44, v45
    v_exp_f32 v48, v48
    v_cvt_pk_bf16_f32 v31, v46, v47
    v_exp_f32 v49, v49
    v_exp_f32 v50, v50
    v_mfma_f32_32x32x16_bf16 v[72:87], v[16:19], v[28:31], v[72:87]
    v_exp_f32 v51, v51
    v_exp_f32 v52, v52
    v_exp_f32 v53, v53
    v_exp_f32 v54, v54
    v_exp_f32 v55, v55
    v_cvt_pk_bf16_f32 v32, v48, v49
    v_cvt_pk_bf16_f32 v33, v50, v51
    v_cvt_pk_bf16_f32 v34, v52, v53
    v_cvt_pk_bf16_f32 v35, v54, v55
    s_setprio 0
    ds_read_b128 v[12:15], v6 offset:36864
    s_mov_b64 exec, s[32:33]
    ds_read_b128 v[16:19], v6 offset:35840
    ds_read_b128 v[20:23], v6 offset:34048
    s_mov_b64 exec, -1
    s_add_u32 s52, s61, 0
    buffer_load_dwordx4 v[104:107], v6, s[20:23], s52 offen sc1
    s_add_u32 m0, s58, 0
    s_add_u32 s52, s60, 0
    buffer_load_dwordx4 v5, s[12:15], s52 offen lds
    s_waitcnt lgkmcnt(0)
    v_exp_f32 v56, v56
    s_setprio 2
    v_exp_f32 v57, v57
    v_mfma_f32_32x32x16_bf16 v[72:87], v[20:23], v[32:35], v[72:87]
    v_exp_f32 v58, v58
    v_exp_f32 v59, v59
    v_exp_f32 v60, v60
    v_exp_f32 v61, v61
    v_mfma_f32_32x32x16_bf16 v[40:55], v[12:15], v[8:11], 0
    v_exp_f32 v62, v62
    v_exp_f32 v63, v63
    v_cvt_pk_bf16_f32 v28, v56, v57
    v_cvt_pk_bf16_f32 v29, v58, v59
    v_cvt_pk_bf16_f32 v30, v60, v61
    v_exp_f32 v64, v64
    v_cvt_pk_bf16_f32 v31, v62, v63
    v_exp_f32 v65, v65
    v_exp_f32 v66, v66
    v_mfma_f32_32x32x16_bf16 v[72:87], v[16:19], v[28:31], v[72:87]
    v_exp_f32 v67, v67
    v_exp_f32 v68, v68
    v_exp_f32 v69, v69
    v_exp_f32 v70, v70
    v_exp_f32 v71, v71
    v_cvt_pk_bf16_f32 v32, v64, v65
    v_cvt_pk_bf16_f32 v33, v66, v67
    v_cvt_pk_bf16_f32 v34, v68, v69
    v_cvt_pk_bf16_f32 v35, v70, v71
    s_setprio 0
    ds_read_b128 v[12:15], v6 offset:38912
    s_mov_b64 exec, s[32:33]
    ds_read_b128 v[16:19], v6 offset:37888
    ds_read_b128 v[20:23], v6 offset:36096
    s_mov_b64 exec, -1
    s_add_u32 s52, s61, 1024
    buffer_load_dwordx4 v[108:111], v6, s[20:23], s52 offen sc1
    s_add_u32 m0, s58, 1024
    s_add_u32 s52, s60, 16384
    buffer_load_dwordx4 v5, s[12:15], s52 offen lds
    s_waitcnt lgkmcnt(0)
    v_exp_f32 v40, v40
    s_setprio 2
    v_exp_f32 v41, v41
    v_mfma_f32_32x32x16_bf16 v[72:87], v[20:23], v[32:35], v[72:87]
    v_exp_f32 v42, v42
    v_exp_f32 v43, v43
    v_exp_f32 v44, v44
    v_exp_f32 v45, v45
    v_mfma_f32_32x32x16_bf16 v[56:71], v[12:15], v[8:11], 0
    v_exp_f32 v46, v46
    v_exp_f32 v47, v47
    v_cvt_pk_bf16_f32 v28, v40, v41
    v_cvt_pk_bf16_f32 v29, v42, v43
    v_cvt_pk_bf16_f32 v30, v44, v45
    v_exp_f32 v48, v48
    v_cvt_pk_bf16_f32 v31, v46, v47
    v_exp_f32 v49, v49
    v_exp_f32 v50, v50
    v_mfma_f32_32x32x16_bf16 v[72:87], v[16:19], v[28:31], v[72:87]
    v_exp_f32 v51, v51
    v_exp_f32 v52, v52
    v_exp_f32 v53, v53
    v_exp_f32 v54, v54
    v_exp_f32 v55, v55
    v_cvt_pk_bf16_f32 v32, v48, v49
    v_cvt_pk_bf16_f32 v33, v50, v51
    v_cvt_pk_bf16_f32 v34, v52, v53
    v_cvt_pk_bf16_f32 v35, v54, v55
    s_setprio 0
    ds_read_b128 v[12:15], v6 offset:40960
    s_mov_b64 exec, s[32:33]
    ds_read_b128 v[16:19], v6 offset:39936
    ds_read_b128 v[20:23], v6 offset:38144
    s_mov_b64 exec, -1
    s_add_u32 s52, s61, 2048
    buffer_load_dwordx4 v[112:115], v6, s[20:23], s52 offen sc1
    s_add_u32 m0, s58, 2048
    s_add_u32 s52, s60, 32768
    buffer_load_dwordx4 v5, s[12:15], s52 offen lds
    s_waitcnt lgkmcnt(0)
    v_exp_f32 v56, v56
    s_setprio 2
    v_exp_f32 v57, v57
    v_mfma_f32_32x32x16_bf16 v[72:87], v[20:23], v[32:35], v[72:87]
    v_exp_f32 v58, v58
    v_exp_f32 v59, v59
    v_exp_f32 v60, v60
    v_exp_f32 v61, v61
    v_mfma_f32_32x32x16_bf16 v[40:55], v[12:15], v[8:11], 0
    v_exp_f32 v62, v62
    v_exp_f32 v63, v63
    v_cvt_pk_bf16_f32 v28, v56, v57
    v_cvt_pk_bf16_f32 v29, v58, v59
    v_cvt_pk_bf16_f32 v30, v60, v61
    v_exp_f32 v64, v64
    v_cvt_pk_bf16_f32 v31, v62, v63
    v_exp_f32 v65, v65
    v_exp_f32 v66, v66
    v_mfma_f32_32x32x16_bf16 v[72:87], v[16:19], v[28:31], v[72:87]
    v_exp_f32 v67, v67
    v_exp_f32 v68, v68
    v_exp_f32 v69, v69
    v_exp_f32 v70, v70
    v_exp_f32 v71, v71
    v_cvt_pk_bf16_f32 v32, v64, v65
    v_cvt_pk_bf16_f32 v33, v66, v67
    v_cvt_pk_bf16_f32 v34, v68, v69
    v_cvt_pk_bf16_f32 v35, v70, v71
    s_mov_b32 s35, 10
L_gated_mix__mha_block__dense_activation_squared_relu__prompt_kernel_loop:
    s_setprio 0
    ds_read_b128 v[12:15], v2 offset:4096
    s_mov_b64 exec, s[32:33]
    ds_read_b128 v[16:19], v2 offset:3072
    ds_read_b128 v[20:23], v2 offset:1280
    s_mov_b64 exec, -1
    s_waitcnt vmcnt(4)
    ds_read_b64_tr_b16 v[36:37], v4 offset:0
    ds_read_b64_tr_b16 v[38:39], v4 offset:512
    s_add_u32 s52, s61, 3072
    buffer_load_dwordx4 v[116:119], v6, s[20:23], s52 offen sc1
    s_add_u32 m0, s58, 3072
    s_add_u32 s52, s60, 49152
    buffer_load_dwordx4 v5, s[12:15], s52 offen lds
    s_waitcnt lgkmcnt(0)
    v_exp_f32 v40, v40
    s_setprio 2
    v_exp_f32 v41, v41
    v_mfma_f32_32x32x16_bf16 v[72:87], v[20:23], v[32:35], v[72:87]
    v_exp_f32 v42, v42
    v_exp_f32 v43, v43
    v_exp_f32 v44, v44
    v_exp_f32 v45, v45
    v_mfma_f32_32x32x16_bf16 v[56:71], v[12:15], v[8:11], 0
    v_exp_f32 v46, v46
    v_exp_f32 v47, v47
    v_cvt_pk_bf16_f32 v28, v40, v41
    v_cvt_pk_bf16_f32 v29, v42, v43
    v_cvt_pk_bf16_f32 v30, v44, v45
    v_exp_f32 v48, v48
    v_cvt_pk_bf16_f32 v31, v46, v47
    v_exp_f32 v49, v49
    v_exp_f32 v50, v50
    v_mfma_f32_32x32x16_bf16 v[72:87], v[16:19], v[28:31], v[72:87]
    v_exp_f32 v51, v51
    v_exp_f32 v52, v52
    v_exp_f32 v53, v53
    v_exp_f32 v54, v54
    v_mfma_f32_32x32x16_bf16 v[88:103], v[36:39], v[104:107], v[88:103]
    v_exp_f32 v55, v55
    v_cvt_pk_bf16_f32 v32, v48, v49
    v_cvt_pk_bf16_f32 v33, v50, v51
    v_cvt_pk_bf16_f32 v34, v52, v53
    v_cvt_pk_bf16_f32 v35, v54, v55
    s_setprio 0
    ds_read_b128 v[12:15], v2 offset:6144
    s_mov_b64 exec, s[32:33]
    ds_read_b128 v[16:19], v2 offset:5120
    ds_read_b128 v[20:23], v2 offset:3328
    s_mov_b64 exec, -1
    s_waitcnt vmcnt(4)
    ds_read_b64_tr_b16 v[36:37], v4 offset:1024
    ds_read_b64_tr_b16 v[38:39], v4 offset:1536
    s_add_u32 s52, s61, 4096
    buffer_load_dwordx4 v[104:107], v6, s[20:23], s52 offen sc1
    s_add_u32 m0, s58, 0
    s_add_u32 s52, s60, 65536
    buffer_load_dwordx4 v5, s[12:15], s52 offen lds
    s_waitcnt lgkmcnt(0)
    v_exp_f32 v56, v56
    s_setprio 2
    v_exp_f32 v57, v57
    v_mfma_f32_32x32x16_bf16 v[72:87], v[20:23], v[32:35], v[72:87]
    v_exp_f32 v58, v58
    v_exp_f32 v59, v59
    v_exp_f32 v60, v60
    v_exp_f32 v61, v61
    v_mfma_f32_32x32x16_bf16 v[40:55], v[12:15], v[8:11], 0
    v_exp_f32 v62, v62
    v_exp_f32 v63, v63
    v_cvt_pk_bf16_f32 v28, v56, v57
    v_cvt_pk_bf16_f32 v29, v58, v59
    v_cvt_pk_bf16_f32 v30, v60, v61
    v_exp_f32 v64, v64
    v_cvt_pk_bf16_f32 v31, v62, v63
    v_exp_f32 v65, v65
    v_exp_f32 v66, v66
    v_mfma_f32_32x32x16_bf16 v[72:87], v[16:19], v[28:31], v[72:87]
    v_exp_f32 v67, v67
    v_exp_f32 v68, v68
    v_exp_f32 v69, v69
    v_exp_f32 v70, v70
    v_mfma_f32_32x32x16_bf16 v[88:103], v[36:39], v[108:111], v[88:103]
    v_exp_f32 v71, v71
    v_cvt_pk_bf16_f32 v32, v64, v65
    v_cvt_pk_bf16_f32 v33, v66, v67
    v_cvt_pk_bf16_f32 v34, v68, v69
    v_cvt_pk_bf16_f32 v35, v70, v71
    s_setprio 0
    ds_read_b128 v[12:15], v2 offset:8192
    s_mov_b64 exec, s[32:33]
    ds_read_b128 v[16:19], v2 offset:7168
    ds_read_b128 v[20:23], v2 offset:5376
    s_mov_b64 exec, -1
    s_waitcnt vmcnt(4)
    ds_read_b64_tr_b16 v[36:37], v4 offset:2048
    ds_read_b64_tr_b16 v[38:39], v4 offset:2560
    s_add_u32 s52, s61, 5120
    buffer_load_dwordx4 v[108:111], v6, s[20:23], s52 offen sc1
    s_add_u32 m0, s58, 1024
    s_add_u32 s52, s60, 81920
    buffer_load_dwordx4 v5, s[12:15], s52 offen lds
    s_waitcnt lgkmcnt(0)
    v_exp_f32 v40, v40
    s_setprio 2
    v_exp_f32 v41, v41
    v_mfma_f32_32x32x16_bf16 v[72:87], v[20:23], v[32:35], v[72:87]
    v_exp_f32 v42, v42
    v_exp_f32 v43, v43
    v_exp_f32 v44, v44
    v_exp_f32 v45, v45
    v_mfma_f32_32x32x16_bf16 v[56:71], v[12:15], v[8:11], 0
    v_exp_f32 v46, v46
    v_exp_f32 v47, v47
    v_cvt_pk_bf16_f32 v28, v40, v41
    v_cvt_pk_bf16_f32 v29, v42, v43
    v_cvt_pk_bf16_f32 v30, v44, v45
    v_exp_f32 v48, v48
    v_cvt_pk_bf16_f32 v31, v46, v47
    v_exp_f32 v49, v49
    v_exp_f32 v50, v50
    v_mfma_f32_32x32x16_bf16 v[72:87], v[16:19], v[28:31], v[72:87]
    v_exp_f32 v51, v51
    v_exp_f32 v52, v52
    v_exp_f32 v53, v53
    v_exp_f32 v54, v54
    v_mfma_f32_32x32x16_bf16 v[88:103], v[36:39], v[112:115], v[88:103]
    v_exp_f32 v55, v55
    v_cvt_pk_bf16_f32 v32, v48, v49
    v_cvt_pk_bf16_f32 v33, v50, v51
    v_cvt_pk_bf16_f32 v34, v52, v53
    v_cvt_pk_bf16_f32 v35, v54, v55
    s_setprio 0
    ds_read_b128 v[12:15], v2 offset:10240
    s_mov_b64 exec, s[32:33]
    ds_read_b128 v[16:19], v2 offset:9216
    ds_read_b128 v[20:23], v2 offset:7424
    s_mov_b64 exec, -1
    s_waitcnt vmcnt(4)
    ds_read_b64_tr_b16 v[36:37], v4 offset:3072
    ds_read_b64_tr_b16 v[38:39], v4 offset:3584
    s_add_u32 s52, s61, 6144
    buffer_load_dwordx4 v[112:115], v6, s[20:23], s52 offen sc1
    s_add_u32 m0, s58, 2048
    s_add_u32 s52, s60, 98304
    buffer_load_dwordx4 v5, s[12:15], s52 offen lds
    s_waitcnt lgkmcnt(0)
    s_add_u32 s61, s61, 4096
    s_add_u32 s60, s60, 65536
    s_sub_u32 s35, s35, 1
    v_exp_f32 v56, v56
    s_setprio 2
    v_exp_f32 v57, v57
    v_mfma_f32_32x32x16_bf16 v[72:87], v[20:23], v[32:35], v[72:87]
    v_exp_f32 v58, v58
    v_exp_f32 v59, v59
    v_exp_f32 v60, v60
    v_exp_f32 v61, v61
    v_mfma_f32_32x32x16_bf16 v[40:55], v[12:15], v[8:11], 0
    v_exp_f32 v62, v62
    v_exp_f32 v63, v63
    v_cvt_pk_bf16_f32 v28, v56, v57
    v_cvt_pk_bf16_f32 v29, v58, v59
    v_cvt_pk_bf16_f32 v30, v60, v61
    v_exp_f32 v64, v64
    v_cvt_pk_bf16_f32 v31, v62, v63
    v_exp_f32 v65, v65
    v_exp_f32 v66, v66
    v_mfma_f32_32x32x16_bf16 v[72:87], v[16:19], v[28:31], v[72:87]
    v_exp_f32 v67, v67
    v_exp_f32 v68, v68
    v_exp_f32 v69, v69
    v_exp_f32 v70, v70
    v_mfma_f32_32x32x16_bf16 v[88:103], v[36:39], v[116:119], v[88:103]
    v_exp_f32 v71, v71
    v_cvt_pk_bf16_f32 v32, v64, v65
    v_cvt_pk_bf16_f32 v33, v66, v67
    v_cvt_pk_bf16_f32 v34, v68, v69
    v_cvt_pk_bf16_f32 v35, v70, v71
    v_add_u32 v2, 8192, v2
    s_cmp_lg_u32 s35, 0
    s_cbranch_scc1 L_gated_mix__mha_block__dense_activation_squared_relu__prompt_kernel_loop
    s_setprio 0
    ds_read_b128 v[12:15], v3 offset:59392
    s_mov_b64 exec, s[32:33]
    ds_read_b128 v[16:19], v3 offset:58368
    ds_read_b128 v[20:23], v3 offset:56576
    s_mov_b64 exec, -1
    s_waitcnt vmcnt(4)
    ds_read_b64_tr_b16 v[36:37], v4 offset:0
    ds_read_b64_tr_b16 v[38:39], v4 offset:512
    s_waitcnt lgkmcnt(0)
    v_exp_f32 v40, v40
    s_setprio 2
    v_exp_f32 v41, v41
    v_mfma_f32_32x32x16_bf16 v[72:87], v[20:23], v[32:35], v[72:87]
    v_exp_f32 v42, v42
    v_exp_f32 v43, v43
    v_exp_f32 v44, v44
    v_exp_f32 v45, v45
    v_mfma_f32_32x32x16_bf16 v[56:71], v[12:15], v[8:11], 0
    v_exp_f32 v46, v46
    v_exp_f32 v47, v47
    v_cvt_pk_bf16_f32 v28, v40, v41
    v_cvt_pk_bf16_f32 v29, v42, v43
    v_cvt_pk_bf16_f32 v30, v44, v45
    v_exp_f32 v48, v48
    v_cvt_pk_bf16_f32 v31, v46, v47
    v_exp_f32 v49, v49
    v_exp_f32 v50, v50
    v_mfma_f32_32x32x16_bf16 v[72:87], v[16:19], v[28:31], v[72:87]
    v_exp_f32 v51, v51
    v_exp_f32 v52, v52
    v_exp_f32 v53, v53
    v_exp_f32 v54, v54
    v_mfma_f32_32x32x16_bf16 v[88:103], v[36:39], v[104:107], v[88:103]
    v_exp_f32 v55, v55
    v_cvt_pk_bf16_f32 v32, v48, v49
    v_cvt_pk_bf16_f32 v33, v50, v51
    v_cvt_pk_bf16_f32 v34, v52, v53
    v_cvt_pk_bf16_f32 v35, v54, v55
    s_setprio 0
    ds_read_b128 v[12:15], v3 offset:61440
    s_mov_b64 exec, s[32:33]
    ds_read_b128 v[16:19], v3 offset:60416
    ds_read_b128 v[20:23], v3 offset:58624
    s_mov_b64 exec, -1
    s_waitcnt vmcnt(2)
    ds_read_b64_tr_b16 v[36:37], v4 offset:1024
    ds_read_b64_tr_b16 v[38:39], v4 offset:1536
    s_waitcnt lgkmcnt(0)
    v_exp_f32 v56, v56
    s_setprio 2
    v_exp_f32 v57, v57
    v_mfma_f32_32x32x16_bf16 v[72:87], v[20:23], v[32:35], v[72:87]
    v_exp_f32 v58, v58
    v_exp_f32 v59, v59
    v_exp_f32 v60, v60
    v_exp_f32 v61, v61
    v_mfma_f32_32x32x16_bf16 v[40:55], v[12:15], v[8:11], 0
    v_exp_f32 v62, v62
    v_exp_f32 v63, v63
    v_cvt_pk_bf16_f32 v28, v56, v57
    v_cvt_pk_bf16_f32 v29, v58, v59
    v_cvt_pk_bf16_f32 v30, v60, v61
    v_exp_f32 v64, v64
    v_cvt_pk_bf16_f32 v31, v62, v63
    v_exp_f32 v65, v65
    v_exp_f32 v66, v66
    v_mfma_f32_32x32x16_bf16 v[72:87], v[16:19], v[28:31], v[72:87]
    v_exp_f32 v67, v67
    v_exp_f32 v68, v68
    v_exp_f32 v69, v69
    v_exp_f32 v70, v70
    v_mfma_f32_32x32x16_bf16 v[88:103], v[36:39], v[108:111], v[88:103]
    v_exp_f32 v71, v71
    v_cvt_pk_bf16_f32 v32, v64, v65
    v_cvt_pk_bf16_f32 v33, v66, v67
    v_cvt_pk_bf16_f32 v34, v68, v69
    v_cvt_pk_bf16_f32 v35, v70, v71
    s_setprio 0
    ds_read_b128 v[12:15], v3 offset:63488
    s_mov_b64 exec, s[32:33]
    ds_read_b128 v[16:19], v3 offset:62464
    ds_read_b128 v[20:23], v3 offset:60672
    s_mov_b64 exec, -1
    s_waitcnt vmcnt(0)
    ds_read_b64_tr_b16 v[36:37], v4 offset:2048
    ds_read_b64_tr_b16 v[38:39], v4 offset:2560
    s_waitcnt lgkmcnt(0)
    v_exp_f32 v40, v40
    s_setprio 2
    v_exp_f32 v41, v41
    v_mfma_f32_32x32x16_bf16 v[72:87], v[20:23], v[32:35], v[72:87]
    v_exp_f32 v42, v42
    v_exp_f32 v43, v43
    v_exp_f32 v44, v44
    v_exp_f32 v45, v45
    v_mfma_f32_32x32x16_bf16 v[56:71], v[12:15], v[8:11], 0
    v_exp_f32 v46, v46
    v_exp_f32 v47, v47
    v_cvt_pk_bf16_f32 v28, v40, v41
    v_cvt_pk_bf16_f32 v29, v42, v43
    v_cvt_pk_bf16_f32 v30, v44, v45
    v_exp_f32 v48, v48
    v_cvt_pk_bf16_f32 v31, v46, v47
    v_exp_f32 v49, v49
    v_exp_f32 v50, v50
    v_mfma_f32_32x32x16_bf16 v[72:87], v[16:19], v[28:31], v[72:87]
    v_exp_f32 v51, v51
    v_exp_f32 v52, v52
    v_exp_f32 v53, v53
    v_exp_f32 v54, v54
    v_mfma_f32_32x32x16_bf16 v[88:103], v[36:39], v[112:115], v[88:103]
    v_exp_f32 v55, v55
    v_cvt_pk_bf16_f32 v32, v48, v49
    v_cvt_pk_bf16_f32 v33, v50, v51
    v_cvt_pk_bf16_f32 v34, v52, v53
    v_cvt_pk_bf16_f32 v35, v54, v55
    s_setprio 0
    s_mov_b64 exec, s[32:33]
    ds_read_b128 v[16:19], v3 offset:64512
    ds_read_b128 v[20:23], v3 offset:62720
    s_mov_b64 exec, -1
    s_waitcnt lgkmcnt(0)
    v_exp_f32 v56, v56
    s_setprio 2
    v_exp_f32 v57, v57
    v_mfma_f32_32x32x16_bf16 v[72:87], v[20:23], v[32:35], v[72:87]
    v_exp_f32 v58, v58
    v_exp_f32 v59, v59
    v_exp_f32 v60, v60
    v_exp_f32 v61, v61
    v_exp_f32 v62, v62
    v_exp_f32 v63, v63
    v_cvt_pk_bf16_f32 v28, v56, v57
    v_cvt_pk_bf16_f32 v29, v58, v59
    v_cvt_pk_bf16_f32 v30, v60, v61
    v_exp_f32 v64, v64
    v_cvt_pk_bf16_f32 v31, v62, v63
    v_exp_f32 v65, v65
    v_exp_f32 v66, v66
    v_mfma_f32_32x32x16_bf16 v[72:87], v[16:19], v[28:31], v[72:87]
    v_exp_f32 v67, v67
    v_exp_f32 v68, v68
    v_exp_f32 v69, v69
    v_exp_f32 v70, v70
    v_exp_f32 v71, v71
    v_cvt_pk_bf16_f32 v32, v64, v65
    v_cvt_pk_bf16_f32 v33, v66, v67
    v_cvt_pk_bf16_f32 v34, v68, v69
    v_cvt_pk_bf16_f32 v35, v70, v71
    s_setprio 0
    s_mov_b64 exec, s[32:33]
    ds_read_b128 v[20:23], v3 offset:64768
    s_mov_b64 exec, -1
    s_waitcnt lgkmcnt(0)
    s_nop 1
    v_mfma_f32_32x32x16_bf16 v[72:87], v[20:23], v[32:35], v[72:87]
    s_nop 15
    v_add_f32 v1, |v72|, |v73|
    v_add_f32 v1, v1, |v74|
    v_add_f32 v1, v1, |v75|
    v_add_f32 v1, v1, |v76|
    v_add_f32 v1, v1, |v77|
    v_add_f32 v1, v1, |v78|
    v_add_f32 v1, v1, |v79|
    s_mov_b32 s40, 0x21800000
    s_mov_b32 s42, 0x5d800000
    s_mov_b32 s43, 0x7b800000
    v_cmp_lt_f32 s[46:47], s40, v80
    v_cmp_gt_f32 s[52:53], s42, v80
    v_cmp_gt_f32 s[54:55], s43, v1
    s_nop 1
    s_and_b64 s[46:47], s[46:47], s[52:53]
    s_and_b64 s[46:47], s[46:47], s[54:55]
    s_cmp_eq_u64 s[46:47], -1
    s_cbranch_scc0 L_gated_mix__mha_block__dense_activation_squared_relu__prompt_kernel_slow
L_gated_mix__mha_block__dense_activation_squared_relu__prompt_kernel_fin:
    v_rcp_f32 v1, v80
    s_nop 0
    v_mul_f32 v72, v72, v1
    v_mul_f32 v73, v73, v1
    v_mul_f32 v74, v74, v1
    v_mul_f32 v75, v75, v1
    v_mul_f32 v76, v76, v1
    v_mul_f32 v77, v77, v1
    v_mul_f32 v78, v78, v1
    v_mul_f32 v79, v79, v1
    v_cvt_pk_bf16_f32 v28, v72, v73
    v_cvt_pk_bf16_f32 v29, v74, v75
    v_cvt_pk_bf16_f32 v30, v76, v77
    v_cvt_pk_bf16_f32 v31, v78, v79
    s_lshl_b32 s46, s44, 3
    s_add_u32 s46, s46, s3
    s_lshl_b32 s47, s46, 5
    s_add_u32 s47, s47, s41
    s_lshl_b32 s48, s47, 10
    s_add_u32 s48, s48, 0x600000
    buffer_store_dwordx4 v[28:31], v6, s[20:23], s48 offen sc1
    s_lshl_b32 s47, s47, 2
    s_add_u32 s47, s47, 0xe44000
    s_waitcnt vmcnt(0)
    v_mov_b32 v120, s36
    v_mul_u32_u24 v121, 256, v0
    s_mov_b64 exec, 1
    buffer_store_dword v120, v121, s[20:23], s47 offen sc1
    s_mov_b64 exec, -1
    s_barrier
    s_lshl_b32 s38, s3, 13
    s_lshl_b32 s39, s3, 16
    s_xor_b32 s52, s44, 0
    s_lshl_b32 s52, s52, 7
    s_add_u32 s39, s39, s52
    s_add_u32 m0, s38, 0
    s_add_u32 s52, s39, 0
    buffer_load_dwordx4 v5, s[24:27], s52 offen lds
    s_add_u32 m0, s38, 1024
    s_add_u32 s52, s39, 64
    buffer_load_dwordx4 v5, s[24:27], s52 offen lds
    s_add_u32 m0, s38, 2048
    s_add_u32 s52, s39, 16384
    buffer_load_dwordx4 v5, s[24:27], s52 offen lds
    s_add_u32 m0, s38, 3072
    s_add_u32 s52, s39, 16448
    buffer_load_dwordx4 v5, s[24:27], s52 offen lds
    s_add_u32 m0, s38, 4096
    s_add_u32 s52, s39, 32768
    buffer_load_dwordx4 v5, s[24:27], s52 offen lds
    s_add_u32 m0, s38, 5120
    s_add_u32 s52, s39, 32832
    buffer_load_dwordx4 v5, s[24:27], s52 offen lds
    s_add_u32 m0, s38, 6144
    s_add_u32 s52, s39, 49152
    buffer_load_dwordx4 v5, s[24:27], s52 offen lds
    s_add_u32 m0, s38, 7168
    s_add_u32 s52, s39, 49216
    buffer_load_dwordx4 v5, s[24:27], s52 offen lds
    s_cmp_lg_u32 s49, 0
    s_cbranch_scc1 L_gated_mix__mha_block__dense_activation_squared_relu__prompt_kernel_nobias
    v_lshlrev_b32 v120, 16, v200
    v_and_b32 v121, 0xffff0000, v200
    v_lshlrev_b32 v122, 16, v201
    v_and_b32 v123, 0xffff0000, v201
    v_lshlrev_b32 v124, 16, v202
    v_and_b32 v125, 0xffff0000, v202
    v_lshlrev_b32 v126, 16, v203
    v_and_b32 v127, 0xffff0000, v203
    v_lshlrev_b32 v128, 16, v204
    v_and_b32 v129, 0xffff0000, v204
    v_lshlrev_b32 v130, 16, v205
    v_and_b32 v131, 0xffff0000, v205
    v_lshlrev_b32 v132, 16, v206
    v_and_b32 v133, 0xffff0000, v206
    v_lshlrev_b32 v134, 16, v207
    v_and_b32 v135, 0xffff0000, v207
    v_add_f32 v88, v88, v120
    v_add_f32 v89, v89, v121
    v_add_f32 v90, v90, v122
    v_add_f32 v91, v91, v123
    v_add_f32 v92, v92, v124
    v_add_f32 v93, v93, v125
    v_add_f32 v94, v94, v126
    v_add_f32 v95, v95, v127
    v_add_f32 v96, v96, v128
    v_add_f32 v97, v97, v129
    v_add_f32 v98, v98, v130
    v_add_f32 v99, v99, v131
    v_add_f32 v100, v100, v132
    v_add_f32 v101, v101, v133
    v_add_f32 v102, v102, v134
    v_add_f32 v103, v103, v135
L_gated_mix__mha_block__dense_activation_squared_relu__prompt_kernel_nobias:
    s_cmp_lg_u32 s3, 0
    s_cbranch_scc1 L_gated_mix__mha_block__dense_activation_squared_relu__prompt_kernel_nopollo
    s_lshl_b32 s46, s41, 8
    s_add_u32 s46, s46, 0xe44000
    v_lshlrev_b32 v1, 2, v0
    s_mov_b32 s52, 16384
L_gated_mix__mha_block__dense_activation_squared_relu__prompt_kernel_pollo:
    buffer_load_dword v120, v1, s[20:23], s46 offen sc1
    s_waitcnt vmcnt(0)
    v_cmp_ne_u32 s[54:55], s36, v120
    s_nop 1
    s_cmp_eq_u64 s[54:55], 0
    s_cbranch_scc1 L_gated_mix__mha_block__dense_activation_squared_relu__prompt_kernel_pollo_ok
    s_sleep 2
    s_sub_u32 s52, s52, 1
    s_cmp_lg_u32 s52, 0
    s_cbranch_scc1 L_gated_mix__mha_block__dense_activation_squared_relu__prompt_kernel_pollo
L_gated_mix__mha_block__dense_activation_squared_relu__prompt_kernel_pollo_ok:
L_gated_mix__mha_block__dense_activation_squared_relu__prompt_kernel_nopollo:
    s_waitcnt vmcnt(0)
    s_barrier
    s_lshl_b32 s46, s41, 16
    s_lshl_b32 s47, s3, 13
    s_add_u32 s46, s46, s47
    s_add_u32 s46, s46, 0x600000
    s_add_u32 s47, s47, 65536
    s_add_u32 m0, s47, 0
    s_add_u32 s48, s46, 0
    buffer_load_dwordx4 v6, s[20:23], s48 offen sc1 lds
    s_add_u32 m0, s47, 1024
    s_add_u32 s48, s46, 1024
    buffer_load_dwordx4 v6, s[20:23], s48 offen sc1 lds
    s_add_u32 m0, s47, 2048
    s_add_u32 s48, s46, 2048
    buffer_load_dwordx4 v6, s[20:23], s48 offen sc1 lds
    s_add_u32 m0, s47, 3072
    s_add_u32 s48, s46, 3072
    buffer_load_dwordx4 v6, s[20:23], s48 offen sc1 lds
    s_add_u32 m0, s47, 4096
    s_add_u32 s48, s46, 4096
    buffer_load_dwordx4 v6, s[20:23], s48 offen sc1 lds
    s_add_u32 m0, s47, 5120
    s_add_u32 s48, s46, 5120
    buffer_load_dwordx4 v6, s[20:23], s48 offen sc1 lds
    s_add_u32 m0, s47, 6144
    s_add_u32 s48, s46, 6144
    buffer_load_dwordx4 v6, s[20:23], s48 offen sc1 lds
    s_add_u32 m0, s47, 7168
    s_add_u32 s48, s46, 7168
    buffer_load_dwordx4 v6, s[20:23], s48 offen sc1 lds
    v_and_b32 v1, 31, v0
    v_lshlrev_b32 v120, 2, v1
    s_lshl_b32 s47, s37, 7
    s_add_u32 s47, s47, 0xe00000
    buffer_load_dword v121, v120, s[20:23], s47 offen sc1
    s_lshl_b32 s47, s49, 15
    s_lshr_b32 s48, s3, 1
    s_and_b32 s48, s48, 1
    s_lshl_b32 s48, s48, 10
    s_add_u32 s47, s47, s48
    v_add_u32 v4, s47, v7
    s_and_b32 s47, s3, 1
    s_lshl_b32 s47, s47, 15
    s_lshl_b32 s48, s49, 14
    s_add_u32 s47, s47, s48
    s_add_u32 s47, s47, 65536
    v_add_u32 v2, s47, v6
    s_waitcnt vmcnt(5)
    s_barrier
    ds_read_b64_tr_b16 v[136:137], v4 offset:0
    ds_read_b64_tr_b16 v[138:139], v4 offset:512
    ds_read_b128 v[140:143], v2 offset:0
    ds_read_b64_tr_b16 v[144:145], v4 offset:2048
    ds_read_b64_tr_b16 v[146:147], v4 offset:2560
    ds_read_b128 v[148:151], v2 offset:1024
    ds_read_b64_tr_b16 v[152:153], v4 offset:4096
    ds_read_b64_tr_b16 v[154:155], v4 offset:4608
    ds_read_b128 v[156:159], v2 offset:2048
    ds_read_b64_tr_b16 v[160:161], v4 offset:6144
    ds_read_b64_tr_b16 v[162:163], v4 offset:6656
    ds_read_b128 v[164:167], v2 offset:3072
    s_waitcnt lgkmcnt(9)
    v_mfma_f32_32x32x16_bf16 v[200:215], v[136:139], v[140:143], 0
    ds_read_b64_tr_b16 v[136:137], v4 offset:16384
    ds_read_b64_tr_b16 v[138:139], v4 offset:16896
    ds_read_b128 v[140:143], v2 offset:8192
    s_waitcnt lgkmcnt(9)
    v_mfma_f32_32x32x16_bf16 v[200:215], v[144:147], v[148:151], v[200:215]
    ds_read_b64_tr_b16 v[144:145], v4 offset:18432
    ds_read_b64_tr_b16 v[146:147], v4 offset:18944
    ds_read_b128 v[148:151], v2 offset:9216
    s_waitcnt lgkmcnt(9)
    v_mfma_f32_32x32x16_bf16 v[200:215], v[152:155], v[156:159], v[200:215]
    ds_read_b64_tr_b16 v[152:153], v4 offset:20480
    ds_read_b64_tr_b16 v[154:155], v4 offset:20992
    ds_read_b128 v[156:159], v2 offset:10240
    s_waitcnt lgkmcnt(9)
    v_mfma_f32_32x32x16_bf16 v[200:215], v[160:163], v[164:167], v[200:215]
    ds_read_b64_tr_b16 v[160:161], v4 offset:22528
    ds_read_b64_tr_b16 v[162:163], v4 offset:23040
    ds_read_b128 v[164:167], v2 offset:11264
    s_waitcnt lgkmcnt(9)
    v_mfma_f32_32x32x16_bf16 v[200:215], v[136:139], v[140:143], v[200:215]
    s_waitcnt vmcnt(1)
    s_barrier
    ds_read_b64_tr_b16 v[136:137], v4 offset:8192
    ds_read_b64_tr_b16 v[138:139], v4 offset:8704
    ds_read_b128 v[140:143], v2 offset:4096
    s_waitcnt lgkmcnt(9)
    v_mfma_f32_32x32x16_bf16 v[200:215], v[144:147], v[148:151], v[200:215]
    ds_read_b64_tr_b16 v[144:145], v4 offset:10240
    ds_read_b64_tr_b16 v[146:147], v4 offset:10752
    ds_read_b128 v[148:151], v2 offset:5120
    s_waitcnt lgkmcnt(9)
    v_mfma_f32_32x32x16_bf16 v[200:215], v[152:155], v[156:159], v[200:215]
    ds_read_b64_tr_b16 v[152:153], v4 offset:12288
    ds_read_b64_tr_b16 v[154:155], v4 offset:12800
    ds_read_b128 v[156:159], v2 offset:6144
    s_waitcnt lgkmcnt(9)
    v_mfma_f32_32x32x16_bf16 v[200:215], v[160:163], v[164:167], v[200:215]
    ds_read_b64_tr_b16 v[160:161], v4 offset:14336
    ds_read_b64_tr_b16 v[162:163], v4 offset:14848
    ds_read_b128 v[164:167], v2 offset:7168
    s_waitcnt lgkmcnt(9)
    v_mfma_f32_32x32x16_bf16 v[200:215], v[136:139], v[140:143], v[200:215]
    ds_read_b64_tr_b16 v[136:137], v4 offset:24576
    ds_read_b64_tr_b16 v[138:139], v4 offset:25088
    ds_read_b128 v[140:143], v2 offset:12288
    s_waitcnt lgkmcnt(9)
    v_mfma_f32_32x32x16_bf16 v[200:215], v[144:147], v[148:151], v[200:215]
    ds_read_b64_tr_b16 v[144:145], v4 offset:26624
    ds_read_b64_tr_b16 v[146:147], v4 offset:27136
    ds_read_b128 v[148:151], v2 offset:13312
    s_waitcnt lgkmcnt(9)
    v_mfma_f32_32x32x16_bf16 v[200:215], v[152:155], v[156:159], v[200:215]
    ds_read_b64_tr_b16 v[152:153], v4 offset:28672
    ds_read_b64_tr_b16 v[154:155], v4 offset:29184
    ds_read_b128 v[156:159], v2 offset:14336
    s_waitcnt lgkmcnt(9)
    v_mfma_f32_32x32x16_bf16 v[200:215], v[160:163], v[164:167], v[200:215]
    ds_read_b64_tr_b16 v[160:161], v4 offset:30720
    ds_read_b64_tr_b16 v[162:163], v4 offset:31232
    ds_read_b128 v[164:167], v2 offset:15360
    s_waitcnt lgkmcnt(9)
    v_mfma_f32_32x32x16_bf16 v[200:215], v[136:139], v[140:143], v[200:215]
    s_waitcnt lgkmcnt(6)
    v_mfma_f32_32x32x16_bf16 v[200:215], v[144:147], v[148:151], v[200:215]
    s_waitcnt lgkmcnt(3)
    v_mfma_f32_32x32x16_bf16 v[200:215], v[152:155], v[156:159], v[200:215]
    s_waitcnt lgkmcnt(0)
    v_mfma_f32_32x32x16_bf16 v[200:215], v[160:163], v[164:167], v[200:215]
    s_waitcnt vmcnt(0)
    v_lshlrev_b32 v1, 10, v1
    v_lshrrev_b32 v122, 5, v0
    v_lshlrev_b32 v122, 4, v122
    v_add_u32 v122, v1, v122
    s_lshl_b32 s46, s37, 15
    s_add_u32 s46, s46, s56
    s_nop 7
    s_nop 3
    v_sub_f32 v200, v200, v88
    v_sub_f32 v201, v201, v89
    v_sub_f32 v202, v202, v90
    v_sub_f32 v203, v203, v91
    v_sub_f32 v204, v204, v92
    v_sub_f32 v205, v205, v93
    v_sub_f32 v206, v206, v94
    v_sub_f32 v207, v207, v95
    v_sub_f32 v208, v208, v96
    v_sub_f32 v209, v209, v97
    v_sub_f32 v210, v210, v98
    v_sub_f32 v211, v211, v99
    v_sub_f32 v212, v212, v100
    v_sub_f32 v213, v213, v101
    v_sub_f32 v214, v214, v102
    v_sub_f32 v215, v215, v103
    v_fma_f32 v200, v121, v200, v88
    v_fma_f32 v201, v121, v201, v89
    v_fma_f32 v202, v121, v202, v90
    v_fma_f32 v203, v121, v203, v91
    v_fma_f32 v204, v121, v204, v92
    v_fma_f32 v205, v121, v205, v93
    v_fma_f32 v206, v121, v206, v94
    v_fma_f32 v207, v121, v207, v95
    v_fma_f32 v208, v121, v208, v96
    v_fma_f32 v209, v121, v209, v97
    v_fma_f32 v210, v121, v210, v98
    v_fma_f32 v211, v121, v211, v99
    v_fma_f32 v212, v121, v212, v100
    v_fma_f32 v213, v121, v213, v101
    v_fma_f32 v214, v121, v214, v102
    v_fma_f32 v215, v121, v215, v103
    v_add_u32 v1, s58, v6
    s_cmp_eq_u32 s49, 0
    s_cbranch_scc1 L_gated_mix__mha_block__dense_activation_squared_relu__prompt_kernel_red0
    ds_write_b128 v1, v[200:203] offset:0
    ds_write_b128 v1, v[204:207] offset:1024
    ds_write_b128 v1, v[208:211] offset:2048
    ds_write_b128 v1, v[212:215] offset:3072
    s_waitcnt lgkmcnt(0)
    s_barrier
    s_endpgm
L_gated_mix__mha_block__dense_activation_squared_relu__prompt_kernel_red0:
    s_barrier
    ds_read_b128 v[136:139], v1 offset:16384
    ds_read_b128 v[140:143], v1 offset:17408
    ds_read_b128 v[144:147], v1 offset:18432
    ds_read_b128 v[148:151], v1 offset:19456
    s_waitcnt lgkmcnt(0)
    v_add_f32 v200, v200, v136
    v_add_f32 v201, v201, v137
    v_add_f32 v202, v202, v138
    v_add_f32 v203, v203, v139
    v_add_f32 v204, v204, v140
    v_add_f32 v205, v205, v141
    v_add_f32 v206, v206, v142
    v_add_f32 v207, v207, v143
    v_add_f32 v208, v208, v144
    v_add_f32 v209, v209, v145
    v_add_f32 v210, v210, v146
    v_add_f32 v211, v211, v147
    v_add_f32 v212, v212, v148
    v_add_f32 v213, v213, v149
    v_add_f32 v214, v214, v150
    v_add_f32 v215, v215, v151
    v_cvt_pk_bf16_f32 v152, v200, v201
    v_cvt_pk_bf16_f32 v153, v202, v203
    v_cvt_pk_bf16_f32 v154, v204, v205
    v_cvt_pk_bf16_f32 v155, v206, v207
    v_cvt_pk_bf16_f32 v156, v208, v209
    v_cvt_pk_bf16_f32 v157, v210, v211
    v_cvt_pk_bf16_f32 v158, v212, v213
    v_cvt_pk_bf16_f32 v159, v214, v215
    s_nop 1
    v_permlane32_swap_b32 v152, v154
    v_permlane32_swap_b32 v153, v155
    v_permlane32_swap_b32 v156, v158
    v_permlane32_swap_b32 v157, v159
    buffer_store_dwordx4 v[152:155], v122, s[28:31], s46 offen offset:0
    buffer_store_dwordx4 v[156:159], v122, s[28:31], s46 offen offset:32
    s_or_b32 s47, s2, s3
    s_cmp_lg_u32 s47, 0
    s_cbranch_scc1 L_gated_mix__mha_block__dense_activation_squared_relu__prompt_kernel_noep
    s_mov_b32 s47, 0xe46000
    v_mov_b32 v120, s36
    v_mov_b32 v121, 0
    s_mov_b64 exec, 1
    buffer_store_dword v120, v121, s[20:23], s47 offen sc1
    s_mov_b64 exec, -1
L_gated_mix__mha_block__dense_activation_squared_relu__prompt_kernel_noep:
L_gated_mix__mha_block__dense_activation_squared_relu__prompt_kernel_end:
    s_endpgm
L_gated_mix__mha_block__dense_activation_squared_relu__prompt_kernel_slow:
    v_mov_b32 v120, 0xff800000
    s_add_u32 s46, s45, 0x200000
    s_mov_b32 s40, 64
L_gated_mix__mha_block__dense_activation_squared_relu__prompt_kernel_s1:
    buffer_load_dwordx4 v[12:15], v6, s[20:23], s46 offen sc1
    s_waitcnt vmcnt(0)
    v_mfma_f32_32x32x16_bf16 v[40:55], v[12:15], v[8:11], 0
    s_nop 15
    v_max3_f32 v120, v40, v41, v120
    v_max3_f32 v120, v42, v43, v120
    v_max3_f32 v120, v44, v45, v120
    v_max3_f32 v120, v46, v47, v120
    v_max3_f32 v120, v48, v49, v120
    v_max3_f32 v120, v50, v51, v120
    v_max3_f32 v120, v52, v53, v120
    v_max3_f32 v120, v54, v55, v120
    s_add_u32 s46, s46, 1024
    s_sub_u32 s40, s40, 1
    s_cmp_lg_u32 s40, 0
    s_cbranch_scc1 L_gated_mix__mha_block__dense_activation_squared_relu__prompt_kernel_s1
    v_mov_b32 v122, v120
    s_nop 1
    v_permlane32_swap_b32 v120, v122
    s_nop 1
    v_max_f32 v120, v120, v122
    v_mov_b32 v72, 0
    v_mov_b32 v73, 0
    v_mov_b32 v74, 0
    v_mov_b32 v75, 0
    v_mov_b32 v76, 0
    v_mov_b32 v77, 0
    v_mov_b32 v78, 0
    v_mov_b32 v79, 0
    v_mov_b32 v80, 0
    v_mov_b32 v81, 0
    v_mov_b32 v82, 0
    v_mov_b32 v83, 0
    v_mov_b32 v84, 0
    v_mov_b32 v85, 0
    v_mov_b32 v86, 0
    v_mov_b32 v87, 0
    s_add_u32 s46, s45, 0x200000
    s_add_u32 s47, s45, 0x400000
    s_mov_b32 s40, 64
L_gated_mix__mha_block__dense_activation_squared_relu__prompt_kernel_s2:
    buffer_load_dwordx4 v[12:15], v6, s[20:23], s46 offen sc1
    s_mov_b64 exec, s[32:33]
    buffer_load_dwordx4 v[16:19], v6, s[20:23], s47 offen sc1
    buffer_load_dwordx4 v[20:23], v6, s[20:23], s47 offen offset:256 sc1
    s_mov_b64 exec, -1
    s_waitcnt vmcnt(0)
    v_mfma_f32_32x32x16_bf16 v[40:55], v[12:15], v[8:11], 0
    s_nop 15
    v_sub_f32 v40, v40, v120
    v_sub_f32 v41, v41, v120
    v_sub_f32 v42, v42, v120
    v_sub_f32 v43, v43, v120
    v_sub_f32 v44, v44, v120
    v_sub_f32 v45, v45, v120
    v_sub_f32 v46, v46, v120
    v_sub_f32 v47, v47, v120
    v_sub_f32 v48, v48, v120
    v_sub_f32 v49, v49, v120
    v_sub_f32 v50, v50, v120
    v_sub_f32 v51, v51, v120
    v_sub_f32 v52, v52, v120
    v_sub_f32 v53, v53, v120
    v_sub_f32 v54, v54, v120
    v_sub_f32 v55, v55, v120
    v_exp_f32 v40, v40
    v_exp_f32 v41, v41
    v_exp_f32 v42, v42
    v_exp_f32 v43, v43
    v_exp_f32 v44, v44
    v_exp_f32 v45, v45
    v_exp_f32 v46, v46
    v_exp_f32 v47, v47
    v_exp_f32 v48, v48
    v_exp_f32 v49, v49
    v_exp_f32 v50, v50
    v_exp_f32 v51, v51
    v_exp_f32 v52, v52
    v_exp_f32 v53, v53
    v_exp_f32 v54, v54
    v_exp_f32 v55, v55
    s_nop 0
    v_cvt_pk_bf16_f32 v28, v40, v41
    v_cvt_pk_bf16_f32 v29, v42, v43
    v_cvt_pk_bf16_f32 v30, v44, v45
    v_cvt_pk_bf16_f32 v31, v46, v47
    v_cvt_pk_bf16_f32 v32, v48, v49
    v_cvt_pk_bf16_f32 v33, v50, v51
    v_cvt_pk_bf16_f32 v34, v52, v53
    v_cvt_pk_bf16_f32 v35, v54, v55
    s_nop 1
    v_mfma_f32_32x32x16_bf16 v[72:87], v[16:19], v[28:31], v[72:87]
    v_mfma_f32_32x32x16_bf16 v[72:87], v[20:23], v[32:35], v[72:87]
    s_add_u32 s46, s46, 1024
    s_add_u32 s47, s47, 1024
    s_sub_u32 s40, s40, 1
    s_cmp_lg_u32 s40, 0
    s_cbranch_scc1 L_gated_mix__mha_block__dense_activation_squared_relu__prompt_kernel_s2
    s_nop 15
    s_branch L_gated_mix__mha_block__dense_activation_squared_relu__prompt_kernel_fin
L_gated_mix__mha_block__dense_activation_squared_relu__prompt_kernel_codeend:

.section .rodata,"a"
.p2align 6
.amdhsa_kernel gated_mix__mha_block__dense_activation_squared_relu__prompt_kernel
  .amdhsa_next_free_vgpr 256
  .amdhsa_next_free_sgpr 100
  .amdhsa_accum_offset 256
  .amdhsa_group_segment_fixed_size 0
  .amdhsa_kernarg_size 96
  .amdhsa_user_sgpr_count 2
  .amdhsa_user_sgpr_kernarg_segment_ptr 1
  .amdhsa_system_sgpr_workgroup_id_x 1
.end_amdhsa_kernel
```
